```python
import torch

def _softmax(x, axis=-1):
    return torch.softmax(x, dim=axis)
def _gelu(x):
    return torch.nn.functional.gelu(x, approximate="tanh")
def _silu(x):
    return torch.nn.functional.silu(x)
def _sigmoid(x):
    return torch.sigmoid(x)
def _layernorm(x, axis=-1, eps=1e-5):
    m = x.mean(dim=axis, keepdim=True)
    v = x.var(dim=axis, keepdim=True, unbiased=False)
    return (x - m) / torch.sqrt(v + eps)
def _scatter_add(tgt, idx, src, axis=0):
    return tgt.clone().index_add_(axis, idx, src)
def _segment_sum(src, seg, n):
    out = torch.zeros((n,) + src.shape[1:], dtype=src.dtype)
    return out.index_add_(0, seg, src)
def _pad(x, pw):
    flat = tuple(v for pair in reversed(pw) for v in pair)
    return torch.nn.functional.pad(x, flat)

kernel_name = 'sequential_preLN__sliding_block_cached__dense_activation_relu__decode'

def setup_inputs():

    _w = (lambda a: (lambda t: t.to(torch.bfloat16) if t.is_floating_point() else t)(torch.as_tensor(a)))
    def _A_setup():
        B, Sq, D = 8, 1, 576
        Hq, Hkv, Sk, Dh = 32, 16, 8192, 128
        assert Hq % Hkv == 0, (Hq, Hkv)
        return {
            "x": _w((lambda *s: torch.randn(*s, dtype=torch.bfloat16) * 0.05)(B, Sq, D)),
            "k_cache": _w((lambda *s: torch.randn(*s, dtype=torch.bfloat16) * 3.2)(B, Hkv, Sk, Dh)),
            "v_cache": _w((lambda *s: torch.randn(*s, dtype=torch.bfloat16) * 0.4)(B, Hkv, Sk, Dh)),
            "wq": _w((lambda *s: torch.randn(*s, dtype=torch.bfloat16) * 3.2)(D, Hq * Dh) * (D ** -0.5)),
            "wo": _w((lambda *s: torch.randn(*s, dtype=torch.bfloat16) * 0.4)(Hq * Dh, D) * ((Hq * Dh) ** -0.5)),
        }
    _A_in = _A_setup()

    def _B_setup():
        B, S, D, Dff = 8, 1, 576, 4608
        return {
            "x": _w((lambda *s: torch.randn(*s, dtype=torch.bfloat16) * 0.05)(B, S, D)),
            "w1": _w((lambda *s: torch.randn(*s, dtype=torch.bfloat16) * 0.05)(D, Dff)),
            "w2": _w((lambda *s: torch.randn(*s, dtype=torch.bfloat16) * 0.05)(Dff, D)),
        }
    _B_in = _B_setup()

    return {
        "A_x": _A_in["x"],
        "A_k_cache": _A_in["k_cache"],
        "A_v_cache": _A_in["v_cache"],
        "A_wq": _A_in["wq"],
        "A_wo": _A_in["wo"],
        "B_x": _B_in["x"],
        "B_w1": _B_in["w1"],
        "B_w2": _B_in["w2"],
    }

def reference(A_x, A_k_cache, A_v_cache, A_wq, A_wo, B_x, B_w1, B_w2):
    def _A_ref(x, k_cache, v_cache, wq, wo):
        B, Sq, D = x.shape
        Hq, Dh = 32, 128
        Hkv, Sk = k_cache.shape[1], k_cache.shape[2]
        W = min(4096, max(256, Sk // 4))
        rep = Hq // Hkv
        q = (lambda x, *d: x.permute(*d))((x @ wq).reshape(B, Sq, Hq, Dh), 0, 2, 1, 3)
        k = (lambda x, n, axis: torch.repeat_interleave(x, n, dim=axis))(k_cache[:, :, Sk - W:, :], rep, axis=1)
        v = (lambda x, n, axis: torch.repeat_interleave(x, n, dim=axis))(v_cache[:, :, Sk - W:, :], rep, axis=1)
        scores = torch.einsum("bhqd,bhkd->bhqk", q, k) * (Dh ** -0.5)
        p = _softmax(scores, axis=-1)
        o = torch.einsum("bhqk,bhkd->bhqd", p, v)
        return (lambda x, *d: x.permute(*d))(o, 0, 2, 1, 3).reshape(B, Sq, Hq * Dh) @ wo

    def _B_ref(x, w1, w2):
        h = torch.einsum("bsd,df->bsf", x, w1)
        zero = torch.zeros_like(h)
        h = torch.maximum(h, zero)
        return torch.einsum("bsf,fd->bsd", h, w2)

    x = A_x
    h = x + _A_ref(_layernorm(x, axis=-1), A_k_cache, A_v_cache, A_wq, A_wo)
    h2 = h + _B_ref(_layernorm(h, axis=-1), B_w1, B_w2)
    return h2
```

```asm
; @launch grid=(256,1,1) block=(512,1,1) lds=159232
.amdgcn_target "amdgcn-amd-amdhsa--gfx950"
.text
.globl sequential_preLN__sliding_block_cached__dense_activation_relu__decode_kernel
.p2align 8
.type sequential_preLN__sliding_block_cached__dense_activation_relu__decode_kernel,@function
sequential_preLN__sliding_block_cached__dense_activation_relu__decode_kernel:
    s_cmp_ge_u32 s2, 256
    s_cbranch_scc1 L_end
    s_load_dwordx16 s[4:19], s[0:1], 0
    s_load_dwordx4 s[20:23], s[0:1], 64
    s_load_dwordx2 s[24:25], s[0:1], 80
    s_setprio 3
    v_lshrrev_b32 v32, 6, v0
    v_and_b32 v1, 63, v0
    v_readfirstlane_b32 s3, v32
    s_and_b32 s60, s2, 127
    s_lshr_b32 s62, s2, 7
    s_bitcmp1_b32 s60, 1
    s_cselect_b32 s66, 1, 5
    s_mul_i32 s66, s66, s62
    s_xor_b32 s60, s60, s66
    v_lshrrev_b32 v41, 4, v1
    v_bfe_u32 v42, v1, 2, 2
    v_and_b32 v43, 3, v1
    s_cmp_lt_u32 s60, 112
    s_cselect_b32 s84, 29, 32
    s_cmp_lt_u32 s60, 64
    s_cselect_b32 s84, 28, s84
    s_lshr_b32 s66, s60, 3
    s_cmp_eq_u32 s66, 3
    s_cselect_b32 s84, 27, s84
    v_lshlrev_b32 v2, 8, v42
    v_lshl_add_u32 v2, v41, 6, v2
    v_lshl_add_u32 v2, v43, 4, v2
    s_bitcmp1_b32 0x47474747, s60
    s_cselect_b32 s66, 1, -1
    s_add_u32 s84, s84, s66
    s_max_u32 s84, s84, 26
    s_sub_u32 s85, 64, s84
    s_lshl_b32 s66, s84, 13
    s_cmp_eq_u32 s62, 0
    s_cselect_b32 s85, s84, s85
    s_cselect_b32 s84, 0, s66
    s_lshl_b32 s63, s60, 21
    s_add_u32 s63, s63, s84
    s_lshl_b32 s30, s85, 10
    s_mul_i32 s66, s3, s30
    s_add_u32 s63, s63, s66
    s_add_u32 s63, s63, 0x180000
    s_mul_i32 s70, s2, 5
    s_add_u32 s70, s70, s3
    s_and_b32 s70, s70, 31
    s_cmp_ge_u32 s70, 26
    s_cselect_b32 s66, 26, 0
    s_sub_u32 s70, s70, s66
    s_lshl_b32 s70, s70, 10
    s_mov_b32 s71, s70
    s_mov_b32 s31, 0x20000
    s_mov_b32 s72, 0
    s_cmp_lt_u32 s2, 64
    s_waitcnt lgkmcnt(0)
    s_cbranch_scc1 L_pro_q
    s_add_u32 s28, s6, s63
    s_addc_u32 s29, s7, 0
    buffer_load_dwordx4 v[96:99], v2, s[28:31], s70 offen nt
    s_add_u32 s70, s70, 1024
    s_cmp_eq_u32 s70, 26624
    s_cselect_b32 s70, 0, s70
    buffer_load_dwordx4 v[100:103], v2, s[28:31], s70 offen nt
    s_add_u32 s70, s70, 1024
    s_cmp_eq_u32 s70, 26624
    s_cselect_b32 s70, 0, s70
    buffer_load_dwordx4 v[104:107], v2, s[28:31], s70 offen nt
    s_add_u32 s70, s70, 1024
    s_cmp_eq_u32 s70, 26624
    s_cselect_b32 s70, 0, s70
    buffer_load_dwordx4 v[108:111], v2, s[28:31], s70 offen nt
    s_add_u32 s70, s70, 1024
    s_cmp_eq_u32 s70, 26624
    s_cselect_b32 s70, 0, s70
    s_setprio 0
    v_and_b32 v56, 7, v1
    v_bfe_u32 v57, v1, 3, 1
    v_lshrrev_b32 v58, 3, v1
    v_bfe_u32 v59, v1, 4, 1
    s_and_b32 s66, s3, 1
    s_lshl_b32 s66, s66, 1
    v_or_b32 v59, s66, v59
    v_lshlrev_b32 v59, 1, v59
    v_xor_b32 v59, v59, v56
    v_lshlrev_b32 v59, 4, v59
    s_mov_b32 s40, s4
    s_mov_b32 s41, s5
    s_mov_b32 s42, 9216
    s_mov_b32 s43, 0x20000
    s_branch L_pro_join
L_pro_q:
    v_and_b32 v56, 7, v1
    v_bfe_u32 v57, v1, 3, 1
    v_lshrrev_b32 v58, 3, v1
    v_bfe_u32 v59, v1, 4, 1
    s_and_b32 s66, s3, 1
    s_lshl_b32 s66, s66, 1
    v_or_b32 v59, s66, v59
    v_lshlrev_b32 v59, 1, v59
    v_xor_b32 v59, v59, v56
    v_lshlrev_b32 v59, 4, v59
    s_mov_b32 s40, s4
    s_mov_b32 s41, s5
    s_mov_b32 s42, 9216
    s_mov_b32 s43, 0x20000
    s_add_u32 s28, s6, s63
    s_addc_u32 s29, s7, 0
    s_and_b32 s73, s2, 7
    s_lshl_b32 s73, s73, 3
    s_lshr_b32 s66, s2, 3
    s_add_u32 s73, s73, s66
    s_mov_b32 s72, 2
    s_cmp_ge_u32 s3, 4
    s_cbranch_scc1 L_pro_dma
    s_mov_b32 s72, 1
    v_mul_u32_u24 v32, 1152, v56
    v_lshl_add_u32 v32, v57, 6, v32
    v_lshl_add_u32 v32, v41, 4, v32
    v_lshlrev_b32 v33, 4, v1
    s_mul_i32 s66, s3, 9216
    s_add_u32 s66, s66, 85504
    v_add_u32 v32, s66, v32
    s_mov_b32 m0, s66
    s_mov_b32 s68, 0
    s_add_u32 s66, s66, 4096
    buffer_load_dwordx4 v33, s[40:43], s68 offen offset:0 lds
    buffer_load_dwordx4 v33, s[40:43], s68 offen offset:1024 lds
    buffer_load_dwordx4 v33, s[40:43], s68 offen offset:2048 lds
    buffer_load_dwordx4 v33, s[40:43], s68 offen offset:3072 lds
    s_mov_b32 m0, s66
    s_mov_b32 s68, 4096
    s_add_u32 s66, s66, 4096
    buffer_load_dwordx4 v33, s[40:43], s68 offen offset:0 lds
    buffer_load_dwordx4 v33, s[40:43], s68 offen offset:1024 lds
    buffer_load_dwordx4 v33, s[40:43], s68 offen offset:2048 lds
    buffer_load_dwordx4 v33, s[40:43], s68 offen offset:3072 lds
    s_mov_b32 m0, s66
    s_mov_b32 s68, 8192
    s_add_u32 s66, s66, 4096
    buffer_load_dwordx4 v33, s[40:43], s68 offen offset:0 lds
    s_branch L_pro_qj
L_pro_dma:
    v_lshl_add_u32 v37, v58, 13, v59
    s_mov_b32 s47, 0x20000
    s_lshl_b32 s66, s73, 7
    s_mov_b32 s46, 0x480000
    s_sub_u32 s46, s46, s66
    s_add_u32 s44, s10, s66
    s_addc_u32 s45, s11, 0
    s_sub_u32 s68, s3, 4
    s_lshl_b32 s66, s68, 10
    s_add_u32 s66, s66, 11776
    s_lshl_b32 s68, s68, 16
    s_mov_b32 m0, s66
    s_nop 0
    buffer_load_dwordx4 v37, s[44:47], s68 offen nt lds
    s_add_u32 s66, s66, 4096
    s_add_u32 s68, s68, 0x40000
    s_mov_b32 m0, s66
    s_nop 0
    buffer_load_dwordx4 v37, s[44:47], s68 offen nt lds
    s_add_u32 s66, s66, 4096
    s_add_u32 s68, s68, 0x40000
    s_mov_b32 m0, s66
    s_nop 0
    buffer_load_dwordx4 v37, s[44:47], s68 offen nt lds
    s_add_u32 s66, s66, 4096
    s_add_u32 s68, s68, 0x40000
    s_mov_b32 m0, s66
    s_nop 0
    buffer_load_dwordx4 v37, s[44:47], s68 offen nt lds
    s_add_u32 s66, s66, 4096
    s_add_u32 s68, s68, 0x40000
    s_mov_b32 m0, s66
    s_nop 0
    buffer_load_dwordx4 v37, s[44:47], s68 offen nt lds
    s_add_u32 s66, s66, 4096
    s_add_u32 s68, s68, 0x40000
    s_mov_b32 m0, s66
    s_nop 0
    buffer_load_dwordx4 v37, s[44:47], s68 offen nt lds
    s_add_u32 s66, s66, 4096
    s_add_u32 s68, s68, 0x40000
    s_mov_b32 m0, s66
    s_nop 0
    buffer_load_dwordx4 v37, s[44:47], s68 offen nt lds
    s_add_u32 s66, s66, 4096
    s_add_u32 s68, s68, 0x40000
    s_mov_b32 m0, s66
    s_nop 0
    buffer_load_dwordx4 v37, s[44:47], s68 offen nt lds
    s_add_u32 s66, s66, 4096
    s_add_u32 s68, s68, 0x40000
    s_mov_b32 m0, s66
    s_nop 0
    buffer_load_dwordx4 v37, s[44:47], s68 offen nt lds
    s_add_u32 s66, s66, 4096
    s_add_u32 s68, s68, 0x40000
    s_mov_b32 m0, s66
    s_nop 0
    buffer_load_dwordx4 v37, s[44:47], s68 offen nt lds
    s_add_u32 s66, s66, 4096
    s_add_u32 s68, s68, 0x40000
    s_mov_b32 m0, s66
    s_nop 0
    buffer_load_dwordx4 v37, s[44:47], s68 offen nt lds
    s_add_u32 s66, s66, 4096
    s_add_u32 s68, s68, 0x40000
    s_mov_b32 m0, s66
    s_nop 0
    buffer_load_dwordx4 v37, s[44:47], s68 offen nt lds
    s_add_u32 s66, s66, 4096
    s_add_u32 s68, s68, 0x40000
    s_mov_b32 m0, s66
    s_nop 0
    buffer_load_dwordx4 v37, s[44:47], s68 offen nt lds
    s_add_u32 s66, s66, 4096
    s_add_u32 s68, s68, 0x40000
    s_mov_b32 m0, s66
    s_nop 0
    buffer_load_dwordx4 v37, s[44:47], s68 offen nt lds
    s_add_u32 s66, s66, 4096
    s_add_u32 s68, s68, 0x40000
    s_mov_b32 m0, s66
    s_nop 0
    buffer_load_dwordx4 v37, s[44:47], s68 offen nt lds
    s_add_u32 s66, s66, 4096
    s_add_u32 s68, s68, 0x40000
    s_mov_b32 m0, s66
    s_nop 0
    buffer_load_dwordx4 v37, s[44:47], s68 offen nt lds
    s_add_u32 s66, s66, 4096
    s_add_u32 s68, s68, 0x40000
    s_mov_b32 m0, s66
    s_nop 0
    buffer_load_dwordx4 v37, s[44:47], s68 offen nt lds
    s_add_u32 s66, s66, 4096
    s_add_u32 s68, s68, 0x40000
    s_mov_b32 m0, s66
    s_nop 0
    buffer_load_dwordx4 v37, s[44:47], s68 offen nt lds
    buffer_load_dwordx4 v[96:99], v2, s[28:31], s70 offen nt
    s_add_u32 s70, s70, 1024
    s_cmp_eq_u32 s70, 26624
    s_cselect_b32 s70, 0, s70
    buffer_load_dwordx4 v[100:103], v2, s[28:31], s70 offen nt
    s_add_u32 s70, s70, 1024
    s_cmp_eq_u32 s70, 26624
    s_cselect_b32 s70, 0, s70
    buffer_load_dwordx4 v[104:107], v2, s[28:31], s70 offen nt
    s_add_u32 s70, s70, 1024
    s_cmp_eq_u32 s70, 26624
    s_cselect_b32 s70, 0, s70
    buffer_load_dwordx4 v[108:111], v2, s[28:31], s70 offen nt
    s_add_u32 s70, s70, 1024
    s_cmp_eq_u32 s70, 26624
    s_cselect_b32 s70, 0, s70
L_pro_qj:
    s_setprio 0
L_pro_join:
    v_lshlrev_b32 v3, 4, v1
    s_and_b32 s27, s60, 15
    s_lshr_b32 s61, s60, 4
    s_lshl_b32 s26, s27, 4
    s_lshl_b32 s66, s62, 3
    s_add_u32 s26, s26, s66
    s_add_u32 s26, s26, s61
    s_load_dword s96, s[24:25], 0
    s_add_u32 s64, s24, 7340032
    s_addc_u32 s65, s25, 0
    s_load_dword s98, s[64:65], 0
    s_add_u32 s32, s8, s63
    s_addc_u32 s33, s9, 0
    s_mov_b32 s34, s30
    s_mov_b32 s35, 0x20000
    s_mov_b32 s36, s24
    s_mov_b32 s37, s25
    s_mov_b32 s38, 0x1000000
    s_mov_b32 s39, 0x20000
    s_mov_b32 s56, s20
    s_mov_b32 s57, s21
    s_mov_b32 s58, 9216
    s_mov_b32 s59, 0x20000
    s_sub_u32 s67, s2, 64
    s_min_u32 s66, s67, 48
    s_mul_i32 s74, s66, 21846
    s_lshr_b32 s74, s74, 16
    s_mul_i32 s75, s74, 3
    s_sub_u32 s75, s66, s75
    s_mul_i32 s66, s74, 294912
    s_mul_i32 s68, s75, 384
    s_add_u32 s66, s66, s68
    s_add_u32 s48, s12, s66
    s_addc_u32 s49, s13, 0
    s_mov_b32 s50, 0x480000
    s_sub_u32 s50, s50, s66
    s_mov_b32 s51, 0x20000
    s_mov_b32 s63, s2
    s_sub_u32 s66, s2, 112
    s_add_u32 s68, s2, 72
    s_cmp_lt_u32 s66, 16
    s_cselect_b32 s63, s68, s63
    s_sub_u32 s66, s2, 184
    s_sub_u32 s68, s2, 72
    s_cmp_lt_u32 s66, 16
    s_cselect_b32 s63, s68, s63
    s_sub_u32 s81, s63, 184
    s_max_i32 s81, s81, 0
    s_lshl_b32 s66, s81, 3
    s_add_u32 s66, s66, 3
    s_sub_u32 s68, s81, 5
    s_mul_i32 s68, s68, 9363
    s_lshr_b32 s68, s68, 16
    s_add_u32 s68, s68, s81
    s_sub_u32 s68, s68, 9
    s_cmp_lt_u32 s81, 9
    s_cselect_b32 s81, s66, s68
    s_mul_i32 s66, s81, 128
    s_add_u32 s52, s16, s66
    s_addc_u32 s53, s17, 0
    s_mov_b32 s54, 5308416
    s_sub_u32 s54, s54, s66
    s_mov_b32 s55, 0x20000
    s_mul_i32 s66, s81, 73728
    s_add_u32 s76, s18, s66
    s_addc_u32 s77, s19, 0
    s_mov_b32 s78, 73728
    s_mov_b32 s79, 0x20000
    s_cmp_lt_u32 s63, 184
    s_cselect_b32 s54, 0, s54
    s_cselect_b32 s78, 0, s78
    s_mov_b32 s86, 0x3db504f3
    s_mov_b32 s87, 0x3fb8aa3b
    s_mov_b32 s99, 0xffff0000
    s_mov_b32 s69, 0xfffffc00
    v_lshlrev_b32 v52, 3, v1
    v_lshrrev_b32 v45, 1, v56
    v_and_b32 v46, 1, v56
    v_mov_b32 v47, 0xffff
    v_mov_b32 v44, 0xffff0000
    v_cmp_eq_u32 vcc, 1, v46
    s_nop 1
    v_cndmask_b32 v47, v47, v44, vcc
    v_cmp_eq_u32 vcc, 0, v45
    s_nop 1
    v_cndmask_b32 v8, 0, v47, vcc
    v_cmp_eq_u32 vcc, 1, v45
    s_nop 1
    v_cndmask_b32 v9, 0, v47, vcc
    v_cmp_eq_u32 vcc, 2, v45
    s_nop 1
    v_cndmask_b32 v10, 0, v47, vcc
    v_cmp_eq_u32 vcc, 3, v45
    s_nop 1
    v_cndmask_b32 v11, 0, v47, vcc
    v_mul_u32_u24 v53, 2304, v56
    v_lshl_add_u32 v53, v57, 6, v53
    v_lshl_add_u32 v53, v41, 4, v53
    v_lshlrev_b32 v38, 3, v57
    v_lshl_add_u32 v38, v41, 1, v38
    v_lshrrev_b32 v46, 1, v43
    v_add_u32 v38, v38, v46
    v_lshlrev_b32 v38, 9, v38
    v_and_b32 v46, 1, v43
    v_lshl_add_u32 v38, v46, 5, v38
    s_lshl_b32 s82, s27, 13
    s_lshl_b32 s68, s61, 6
    s_add_u32 s82, s82, s68
    s_add_u32 s82, s82, 4194304
    v_mul_u32_u24 v40, 9216, v58
    v_add_u32 v40, v59, v40
    v_mul_u32_u24 v39, 1152, v58
    v_add_u32 v39, v59, v39
    v_cmp_eq_u32 s[88:89], 1, v57
    s_cmp_lg_u32 s72, 1
    s_cbranch_scc1 L_stream_a
    s_waitcnt vmcnt(0)
    ds_read_b128 v[220:223], v32 offset:0
    ds_read_b128 v[224:227], v32 offset:128
    ds_read_b128 v[228:231], v32 offset:256
    ds_read_b128 v[232:235], v32 offset:384
    ds_read_b128 v[236:239], v32 offset:512
    ds_read_b128 v[240:243], v32 offset:640
    ds_read_b128 v[244:247], v32 offset:768
    ds_read_b128 v[248:251], v32 offset:896
    ds_read_b128 v[252:255], v32 offset:1024
    s_waitcnt lgkmcnt(0)
    v_lshlrev_b32 v148, 16, v220
    v_and_b32 v149, 0xffff0000, v220
    v_lshlrev_b32 v150, 16, v221
    v_and_b32 v151, 0xffff0000, v221
    v_lshlrev_b32 v152, 16, v222
    v_and_b32 v153, 0xffff0000, v222
    v_lshlrev_b32 v154, 16, v223
    v_and_b32 v155, 0xffff0000, v223
    v_lshlrev_b32 v156, 16, v224
    v_and_b32 v157, 0xffff0000, v224
    v_lshlrev_b32 v158, 16, v225
    v_and_b32 v159, 0xffff0000, v225
    v_lshlrev_b32 v160, 16, v226
    v_and_b32 v161, 0xffff0000, v226
    v_lshlrev_b32 v162, 16, v227
    v_and_b32 v163, 0xffff0000, v227
    v_lshlrev_b32 v164, 16, v228
    v_and_b32 v165, 0xffff0000, v228
    v_lshlrev_b32 v166, 16, v229
    v_and_b32 v167, 0xffff0000, v229
    v_lshlrev_b32 v168, 16, v230
    v_and_b32 v169, 0xffff0000, v230
    v_lshlrev_b32 v170, 16, v231
    v_and_b32 v171, 0xffff0000, v231
    v_lshlrev_b32 v172, 16, v232
    v_and_b32 v173, 0xffff0000, v232
    v_lshlrev_b32 v174, 16, v233
    v_and_b32 v175, 0xffff0000, v233
    v_lshlrev_b32 v176, 16, v234
    v_and_b32 v177, 0xffff0000, v234
    v_lshlrev_b32 v178, 16, v235
    v_and_b32 v179, 0xffff0000, v235
    v_lshlrev_b32 v180, 16, v236
    v_and_b32 v181, 0xffff0000, v236
    v_lshlrev_b32 v182, 16, v237
    v_and_b32 v183, 0xffff0000, v237
    v_lshlrev_b32 v184, 16, v238
    v_and_b32 v185, 0xffff0000, v238
    v_lshlrev_b32 v186, 16, v239
    v_and_b32 v187, 0xffff0000, v239
    v_lshlrev_b32 v188, 16, v240
    v_and_b32 v189, 0xffff0000, v240
    v_lshlrev_b32 v190, 16, v241
    v_and_b32 v191, 0xffff0000, v241
    v_lshlrev_b32 v192, 16, v242
    v_and_b32 v193, 0xffff0000, v242
    v_lshlrev_b32 v194, 16, v243
    v_and_b32 v195, 0xffff0000, v243
    v_lshlrev_b32 v196, 16, v244
    v_and_b32 v197, 0xffff0000, v244
    v_lshlrev_b32 v198, 16, v245
    v_and_b32 v199, 0xffff0000, v245
    v_lshlrev_b32 v200, 16, v246
    v_and_b32 v201, 0xffff0000, v246
    v_lshlrev_b32 v202, 16, v247
    v_and_b32 v203, 0xffff0000, v247
    v_lshlrev_b32 v204, 16, v248
    v_and_b32 v205, 0xffff0000, v248
    v_lshlrev_b32 v206, 16, v249
    v_and_b32 v207, 0xffff0000, v249
    v_lshlrev_b32 v208, 16, v250
    v_and_b32 v209, 0xffff0000, v250
    v_lshlrev_b32 v210, 16, v251
    v_and_b32 v211, 0xffff0000, v251
    v_lshlrev_b32 v212, 16, v252
    v_and_b32 v213, 0xffff0000, v252
    v_lshlrev_b32 v214, 16, v253
    v_and_b32 v215, 0xffff0000, v253
    v_lshlrev_b32 v216, 16, v254
    v_and_b32 v217, 0xffff0000, v254
    v_lshlrev_b32 v218, 16, v255
    v_and_b32 v219, 0xffff0000, v255
    v_pk_add_f32 v[44:45], v[148:149], v[150:151]
    v_pk_add_f32 v[46:47], v[152:153], v[154:155]
    v_pk_add_f32 v[44:45], v[44:45], v[156:157]
    v_pk_add_f32 v[46:47], v[46:47], v[158:159]
    v_pk_add_f32 v[44:45], v[44:45], v[160:161]
    v_pk_add_f32 v[46:47], v[46:47], v[162:163]
    v_pk_add_f32 v[44:45], v[44:45], v[164:165]
    v_pk_add_f32 v[46:47], v[46:47], v[166:167]
    v_pk_add_f32 v[44:45], v[44:45], v[168:169]
    v_pk_add_f32 v[46:47], v[46:47], v[170:171]
    v_pk_add_f32 v[44:45], v[44:45], v[172:173]
    v_pk_add_f32 v[46:47], v[46:47], v[174:175]
    v_pk_add_f32 v[44:45], v[44:45], v[176:177]
    v_pk_add_f32 v[46:47], v[46:47], v[178:179]
    v_pk_add_f32 v[44:45], v[44:45], v[180:181]
    v_pk_add_f32 v[46:47], v[46:47], v[182:183]
    v_pk_add_f32 v[44:45], v[44:45], v[184:185]
    v_pk_add_f32 v[46:47], v[46:47], v[186:187]
    v_pk_add_f32 v[44:45], v[44:45], v[188:189]
    v_pk_add_f32 v[46:47], v[46:47], v[190:191]
    v_pk_add_f32 v[44:45], v[44:45], v[192:193]
    v_pk_add_f32 v[46:47], v[46:47], v[194:195]
    v_pk_add_f32 v[44:45], v[44:45], v[196:197]
    v_pk_add_f32 v[46:47], v[46:47], v[198:199]
    v_pk_add_f32 v[44:45], v[44:45], v[200:201]
    v_pk_add_f32 v[46:47], v[46:47], v[202:203]
    v_pk_add_f32 v[44:45], v[44:45], v[204:205]
    v_pk_add_f32 v[46:47], v[46:47], v[206:207]
    v_pk_add_f32 v[44:45], v[44:45], v[208:209]
    v_pk_add_f32 v[46:47], v[46:47], v[210:211]
    v_pk_add_f32 v[44:45], v[44:45], v[212:213]
    v_pk_add_f32 v[46:47], v[46:47], v[214:215]
    v_pk_add_f32 v[44:45], v[44:45], v[216:217]
    v_pk_add_f32 v[46:47], v[46:47], v[218:219]
    v_pk_add_f32 v[44:45], v[44:45], v[46:47]
    v_add_f32 v44, v44, v45
    s_nop 1
    v_add_f32_dpp v44, v44, v44 row_ror:8 row_mask:0xf bank_mask:0xf
    v_mov_b32 v46, v44
    s_nop 1
    v_permlane16_swap_b32 v44, v46
    v_add_f32 v44, v44, v46
    v_mov_b32 v46, v44
    s_nop 1
    v_permlane32_swap_b32 v44, v46
    v_add_f32 v44, v44, v46
    v_mul_f32 v44, 0xbae38e39, v44
    v_mov_b32 v45, v44
    v_pk_add_f32 v[46:47], v[148:149], v[44:45]
    v_pk_mul_f32 v[48:49], v[46:47], v[46:47]
    v_pk_add_f32 v[46:47], v[150:151], v[44:45]
    v_pk_fma_f32 v[48:49], v[46:47], v[46:47], v[48:49]
    v_pk_add_f32 v[46:47], v[152:153], v[44:45]
    v_pk_fma_f32 v[48:49], v[46:47], v[46:47], v[48:49]
    v_pk_add_f32 v[46:47], v[154:155], v[44:45]
    v_pk_fma_f32 v[48:49], v[46:47], v[46:47], v[48:49]
    v_pk_add_f32 v[46:47], v[156:157], v[44:45]
    v_pk_fma_f32 v[48:49], v[46:47], v[46:47], v[48:49]
    v_pk_add_f32 v[46:47], v[158:159], v[44:45]
    v_pk_fma_f32 v[48:49], v[46:47], v[46:47], v[48:49]
    v_pk_add_f32 v[46:47], v[160:161], v[44:45]
    v_pk_fma_f32 v[48:49], v[46:47], v[46:47], v[48:49]
    v_pk_add_f32 v[46:47], v[162:163], v[44:45]
    v_pk_fma_f32 v[48:49], v[46:47], v[46:47], v[48:49]
    v_pk_add_f32 v[46:47], v[164:165], v[44:45]
    v_pk_fma_f32 v[48:49], v[46:47], v[46:47], v[48:49]
    v_pk_add_f32 v[46:47], v[166:167], v[44:45]
    v_pk_fma_f32 v[48:49], v[46:47], v[46:47], v[48:49]
    v_pk_add_f32 v[46:47], v[168:169], v[44:45]
    v_pk_fma_f32 v[48:49], v[46:47], v[46:47], v[48:49]
    v_pk_add_f32 v[46:47], v[170:171], v[44:45]
    v_pk_fma_f32 v[48:49], v[46:47], v[46:47], v[48:49]
    v_pk_add_f32 v[46:47], v[172:173], v[44:45]
    v_pk_fma_f32 v[48:49], v[46:47], v[46:47], v[48:49]
    v_pk_add_f32 v[46:47], v[174:175], v[44:45]
    v_pk_fma_f32 v[48:49], v[46:47], v[46:47], v[48:49]
    v_pk_add_f32 v[46:47], v[176:177], v[44:45]
    v_pk_fma_f32 v[48:49], v[46:47], v[46:47], v[48:49]
    v_pk_add_f32 v[46:47], v[178:179], v[44:45]
    v_pk_fma_f32 v[48:49], v[46:47], v[46:47], v[48:49]
    v_pk_add_f32 v[46:47], v[180:181], v[44:45]
    v_pk_fma_f32 v[48:49], v[46:47], v[46:47], v[48:49]
    v_pk_add_f32 v[46:47], v[182:183], v[44:45]
    v_pk_fma_f32 v[48:49], v[46:47], v[46:47], v[48:49]
    v_pk_add_f32 v[46:47], v[184:185], v[44:45]
    v_pk_fma_f32 v[48:49], v[46:47], v[46:47], v[48:49]
    v_pk_add_f32 v[46:47], v[186:187], v[44:45]
    v_pk_fma_f32 v[48:49], v[46:47], v[46:47], v[48:49]
    v_pk_add_f32 v[46:47], v[188:189], v[44:45]
    v_pk_fma_f32 v[48:49], v[46:47], v[46:47], v[48:49]
    v_pk_add_f32 v[46:47], v[190:191], v[44:45]
    v_pk_fma_f32 v[48:49], v[46:47], v[46:47], v[48:49]
    v_pk_add_f32 v[46:47], v[192:193], v[44:45]
    v_pk_fma_f32 v[48:49], v[46:47], v[46:47], v[48:49]
    v_pk_add_f32 v[46:47], v[194:195], v[44:45]
    v_pk_fma_f32 v[48:49], v[46:47], v[46:47], v[48:49]
    v_pk_add_f32 v[46:47], v[196:197], v[44:45]
    v_pk_fma_f32 v[48:49], v[46:47], v[46:47], v[48:49]
    v_pk_add_f32 v[46:47], v[198:199], v[44:45]
    v_pk_fma_f32 v[48:49], v[46:47], v[46:47], v[48:49]
    v_pk_add_f32 v[46:47], v[200:201], v[44:45]
    v_pk_fma_f32 v[48:49], v[46:47], v[46:47], v[48:49]
    v_pk_add_f32 v[46:47], v[202:203], v[44:45]
    v_pk_fma_f32 v[48:49], v[46:47], v[46:47], v[48:49]
    v_pk_add_f32 v[46:47], v[204:205], v[44:45]
    v_pk_fma_f32 v[48:49], v[46:47], v[46:47], v[48:49]
    v_pk_add_f32 v[46:47], v[206:207], v[44:45]
    v_pk_fma_f32 v[48:49], v[46:47], v[46:47], v[48:49]
    v_pk_add_f32 v[46:47], v[208:209], v[44:45]
    v_pk_fma_f32 v[48:49], v[46:47], v[46:47], v[48:49]
    v_pk_add_f32 v[46:47], v[210:211], v[44:45]
    v_pk_fma_f32 v[48:49], v[46:47], v[46:47], v[48:49]
    v_pk_add_f32 v[46:47], v[212:213], v[44:45]
    v_pk_fma_f32 v[48:49], v[46:47], v[46:47], v[48:49]
    v_pk_add_f32 v[46:47], v[214:215], v[44:45]
    v_pk_fma_f32 v[48:49], v[46:47], v[46:47], v[48:49]
    v_pk_add_f32 v[46:47], v[216:217], v[44:45]
    v_pk_fma_f32 v[48:49], v[46:47], v[46:47], v[48:49]
    v_pk_add_f32 v[46:47], v[218:219], v[44:45]
    v_pk_fma_f32 v[48:49], v[46:47], v[46:47], v[48:49]
    v_add_f32 v48, v48, v49
    s_nop 1
    v_add_f32_dpp v48, v48, v48 row_ror:8 row_mask:0xf bank_mask:0xf
    v_mov_b32 v46, v48
    s_nop 1
    v_permlane16_swap_b32 v48, v46
    v_add_f32 v48, v48, v46
    v_mov_b32 v46, v48
    s_nop 1
    v_permlane32_swap_b32 v48, v46
    v_add_f32 v48, v48, v46
    v_mul_f32 v48, 0x3ae38e39, v48
    v_cvt_pk_bf16_f32 v44, v44, v48
    v_and_b32 v48, 0xffff0000, v44
    v_lshlrev_b32 v44, 16, v44
    v_add_f32 v48, 0x3727c5ac, v48
    v_cvt_pk_bf16_f32 v48, v48, v48
    v_and_b32 v48, 0xffff0000, v48
    v_sqrt_f32 v48, v48
    s_nop 0
    v_cvt_pk_bf16_f32 v48, v48, v48
    v_and_b32 v48, 0xffff0000, v48
    v_rcp_f32 v48, v48
    v_mov_b32 v45, v44
    v_mov_b32 v49, v48
    v_pk_add_f32 v[148:149], v[148:149], v[44:45]
    v_pk_add_f32 v[150:151], v[150:151], v[44:45]
    v_pk_add_f32 v[152:153], v[152:153], v[44:45]
    v_pk_add_f32 v[154:155], v[154:155], v[44:45]
    v_pk_add_f32 v[156:157], v[156:157], v[44:45]
    v_pk_add_f32 v[158:159], v[158:159], v[44:45]
    v_pk_add_f32 v[160:161], v[160:161], v[44:45]
    v_pk_add_f32 v[162:163], v[162:163], v[44:45]
    v_pk_add_f32 v[164:165], v[164:165], v[44:45]
    v_pk_add_f32 v[166:167], v[166:167], v[44:45]
    v_pk_add_f32 v[168:169], v[168:169], v[44:45]
    v_pk_add_f32 v[170:171], v[170:171], v[44:45]
    v_pk_add_f32 v[172:173], v[172:173], v[44:45]
    v_pk_add_f32 v[174:175], v[174:175], v[44:45]
    v_pk_add_f32 v[176:177], v[176:177], v[44:45]
    v_pk_add_f32 v[178:179], v[178:179], v[44:45]
    v_pk_add_f32 v[180:181], v[180:181], v[44:45]
    v_pk_add_f32 v[182:183], v[182:183], v[44:45]
    v_pk_add_f32 v[184:185], v[184:185], v[44:45]
    v_pk_add_f32 v[186:187], v[186:187], v[44:45]
    v_pk_add_f32 v[188:189], v[188:189], v[44:45]
    v_pk_add_f32 v[190:191], v[190:191], v[44:45]
    v_pk_add_f32 v[192:193], v[192:193], v[44:45]
    v_pk_add_f32 v[194:195], v[194:195], v[44:45]
    v_pk_add_f32 v[196:197], v[196:197], v[44:45]
    v_pk_add_f32 v[198:199], v[198:199], v[44:45]
    v_pk_add_f32 v[200:201], v[200:201], v[44:45]
    v_pk_add_f32 v[202:203], v[202:203], v[44:45]
    v_pk_add_f32 v[204:205], v[204:205], v[44:45]
    v_pk_add_f32 v[206:207], v[206:207], v[44:45]
    v_pk_add_f32 v[208:209], v[208:209], v[44:45]
    v_pk_add_f32 v[210:211], v[210:211], v[44:45]
    v_pk_add_f32 v[212:213], v[212:213], v[44:45]
    v_pk_add_f32 v[214:215], v[214:215], v[44:45]
    v_pk_add_f32 v[216:217], v[216:217], v[44:45]
    v_pk_add_f32 v[218:219], v[218:219], v[44:45]
    v_cvt_pk_bf16_f32 v220, v148, v149
    v_cvt_pk_bf16_f32 v221, v150, v151
    v_cvt_pk_bf16_f32 v222, v152, v153
    v_cvt_pk_bf16_f32 v223, v154, v155
    v_cvt_pk_bf16_f32 v224, v156, v157
    v_cvt_pk_bf16_f32 v225, v158, v159
    v_cvt_pk_bf16_f32 v226, v160, v161
    v_cvt_pk_bf16_f32 v227, v162, v163
    v_cvt_pk_bf16_f32 v228, v164, v165
    v_cvt_pk_bf16_f32 v229, v166, v167
    v_cvt_pk_bf16_f32 v230, v168, v169
    v_cvt_pk_bf16_f32 v231, v170, v171
    v_cvt_pk_bf16_f32 v232, v172, v173
    v_cvt_pk_bf16_f32 v233, v174, v175
    v_cvt_pk_bf16_f32 v234, v176, v177
    v_cvt_pk_bf16_f32 v235, v178, v179
    v_cvt_pk_bf16_f32 v236, v180, v181
    v_cvt_pk_bf16_f32 v237, v182, v183
    v_cvt_pk_bf16_f32 v238, v184, v185
    v_cvt_pk_bf16_f32 v239, v186, v187
    v_cvt_pk_bf16_f32 v240, v188, v189
    v_cvt_pk_bf16_f32 v241, v190, v191
    v_cvt_pk_bf16_f32 v242, v192, v193
    v_cvt_pk_bf16_f32 v243, v194, v195
    v_cvt_pk_bf16_f32 v244, v196, v197
    v_cvt_pk_bf16_f32 v245, v198, v199
    v_cvt_pk_bf16_f32 v246, v200, v201
    v_cvt_pk_bf16_f32 v247, v202, v203
    v_cvt_pk_bf16_f32 v248, v204, v205
    v_cvt_pk_bf16_f32 v249, v206, v207
    v_cvt_pk_bf16_f32 v250, v208, v209
    v_cvt_pk_bf16_f32 v251, v210, v211
    v_cvt_pk_bf16_f32 v252, v212, v213
    v_cvt_pk_bf16_f32 v253, v214, v215
    v_cvt_pk_bf16_f32 v254, v216, v217
    v_cvt_pk_bf16_f32 v255, v218, v219
    v_lshlrev_b32 v148, 16, v220
    v_and_b32 v149, 0xffff0000, v220
    v_lshlrev_b32 v150, 16, v221
    v_and_b32 v151, 0xffff0000, v221
    v_lshlrev_b32 v152, 16, v222
    v_and_b32 v153, 0xffff0000, v222
    v_lshlrev_b32 v154, 16, v223
    v_and_b32 v155, 0xffff0000, v223
    v_lshlrev_b32 v156, 16, v224
    v_and_b32 v157, 0xffff0000, v224
    v_lshlrev_b32 v158, 16, v225
    v_and_b32 v159, 0xffff0000, v225
    v_lshlrev_b32 v160, 16, v226
    v_and_b32 v161, 0xffff0000, v226
    v_lshlrev_b32 v162, 16, v227
    v_and_b32 v163, 0xffff0000, v227
    v_lshlrev_b32 v164, 16, v228
    v_and_b32 v165, 0xffff0000, v228
    v_lshlrev_b32 v166, 16, v229
    v_and_b32 v167, 0xffff0000, v229
    v_lshlrev_b32 v168, 16, v230
    v_and_b32 v169, 0xffff0000, v230
    v_lshlrev_b32 v170, 16, v231
    v_and_b32 v171, 0xffff0000, v231
    v_lshlrev_b32 v172, 16, v232
    v_and_b32 v173, 0xffff0000, v232
    v_lshlrev_b32 v174, 16, v233
    v_and_b32 v175, 0xffff0000, v233
    v_lshlrev_b32 v176, 16, v234
    v_and_b32 v177, 0xffff0000, v234
    v_lshlrev_b32 v178, 16, v235
    v_and_b32 v179, 0xffff0000, v235
    v_lshlrev_b32 v180, 16, v236
    v_and_b32 v181, 0xffff0000, v236
    v_lshlrev_b32 v182, 16, v237
    v_and_b32 v183, 0xffff0000, v237
    v_lshlrev_b32 v184, 16, v238
    v_and_b32 v185, 0xffff0000, v238
    v_lshlrev_b32 v186, 16, v239
    v_and_b32 v187, 0xffff0000, v239
    v_lshlrev_b32 v188, 16, v240
    v_and_b32 v189, 0xffff0000, v240
    v_lshlrev_b32 v190, 16, v241
    v_and_b32 v191, 0xffff0000, v241
    v_lshlrev_b32 v192, 16, v242
    v_and_b32 v193, 0xffff0000, v242
    v_lshlrev_b32 v194, 16, v243
    v_and_b32 v195, 0xffff0000, v243
    v_lshlrev_b32 v196, 16, v244
    v_and_b32 v197, 0xffff0000, v244
    v_lshlrev_b32 v198, 16, v245
    v_and_b32 v199, 0xffff0000, v245
    v_lshlrev_b32 v200, 16, v246
    v_and_b32 v201, 0xffff0000, v246
    v_lshlrev_b32 v202, 16, v247
    v_and_b32 v203, 0xffff0000, v247
    v_lshlrev_b32 v204, 16, v248
    v_and_b32 v205, 0xffff0000, v248
    v_lshlrev_b32 v206, 16, v249
    v_and_b32 v207, 0xffff0000, v249
    v_lshlrev_b32 v208, 16, v250
    v_and_b32 v209, 0xffff0000, v250
    v_lshlrev_b32 v210, 16, v251
    v_and_b32 v211, 0xffff0000, v251
    v_lshlrev_b32 v212, 16, v252
    v_and_b32 v213, 0xffff0000, v252
    v_lshlrev_b32 v214, 16, v253
    v_and_b32 v215, 0xffff0000, v253
    v_lshlrev_b32 v216, 16, v254
    v_and_b32 v217, 0xffff0000, v254
    v_lshlrev_b32 v218, 16, v255
    v_and_b32 v219, 0xffff0000, v255
    v_pk_mul_f32 v[148:149], v[148:149], v[48:49]
    v_pk_mul_f32 v[150:151], v[150:151], v[48:49]
    v_pk_mul_f32 v[152:153], v[152:153], v[48:49]
    v_pk_mul_f32 v[154:155], v[154:155], v[48:49]
    v_pk_mul_f32 v[156:157], v[156:157], v[48:49]
    v_pk_mul_f32 v[158:159], v[158:159], v[48:49]
    v_pk_mul_f32 v[160:161], v[160:161], v[48:49]
    v_pk_mul_f32 v[162:163], v[162:163], v[48:49]
    v_pk_mul_f32 v[164:165], v[164:165], v[48:49]
    v_pk_mul_f32 v[166:167], v[166:167], v[48:49]
    v_pk_mul_f32 v[168:169], v[168:169], v[48:49]
    v_pk_mul_f32 v[170:171], v[170:171], v[48:49]
    v_pk_mul_f32 v[172:173], v[172:173], v[48:49]
    v_pk_mul_f32 v[174:175], v[174:175], v[48:49]
    v_pk_mul_f32 v[176:177], v[176:177], v[48:49]
    v_pk_mul_f32 v[178:179], v[178:179], v[48:49]
    v_pk_mul_f32 v[180:181], v[180:181], v[48:49]
    v_pk_mul_f32 v[182:183], v[182:183], v[48:49]
    v_pk_mul_f32 v[184:185], v[184:185], v[48:49]
    v_pk_mul_f32 v[186:187], v[186:187], v[48:49]
    v_pk_mul_f32 v[188:189], v[188:189], v[48:49]
    v_pk_mul_f32 v[190:191], v[190:191], v[48:49]
    v_pk_mul_f32 v[192:193], v[192:193], v[48:49]
    v_pk_mul_f32 v[194:195], v[194:195], v[48:49]
    v_pk_mul_f32 v[196:197], v[196:197], v[48:49]
    v_pk_mul_f32 v[198:199], v[198:199], v[48:49]
    v_pk_mul_f32 v[200:201], v[200:201], v[48:49]
    v_pk_mul_f32 v[202:203], v[202:203], v[48:49]
    v_pk_mul_f32 v[204:205], v[204:205], v[48:49]
    v_pk_mul_f32 v[206:207], v[206:207], v[48:49]
    v_pk_mul_f32 v[208:209], v[208:209], v[48:49]
    v_pk_mul_f32 v[210:211], v[210:211], v[48:49]
    v_pk_mul_f32 v[212:213], v[212:213], v[48:49]
    v_pk_mul_f32 v[214:215], v[214:215], v[48:49]
    v_pk_mul_f32 v[216:217], v[216:217], v[48:49]
    v_pk_mul_f32 v[218:219], v[218:219], v[48:49]
    v_cvt_pk_bf16_f32 v220, v148, v149
    v_cvt_pk_bf16_f32 v221, v150, v151
    v_cvt_pk_bf16_f32 v222, v152, v153
    v_cvt_pk_bf16_f32 v223, v154, v155
    v_cvt_pk_bf16_f32 v224, v156, v157
    v_cvt_pk_bf16_f32 v225, v158, v159
    v_cvt_pk_bf16_f32 v226, v160, v161
    v_cvt_pk_bf16_f32 v227, v162, v163
    v_cvt_pk_bf16_f32 v228, v164, v165
    v_cvt_pk_bf16_f32 v229, v166, v167
    v_cvt_pk_bf16_f32 v230, v168, v169
    v_cvt_pk_bf16_f32 v231, v170, v171
    v_cvt_pk_bf16_f32 v232, v172, v173
    v_cvt_pk_bf16_f32 v233, v174, v175
    v_cvt_pk_bf16_f32 v234, v176, v177
    v_cvt_pk_bf16_f32 v235, v178, v179
    v_cvt_pk_bf16_f32 v236, v180, v181
    v_cvt_pk_bf16_f32 v237, v182, v183
    v_cvt_pk_bf16_f32 v238, v184, v185
    v_cvt_pk_bf16_f32 v239, v186, v187
    v_cvt_pk_bf16_f32 v240, v188, v189
    v_cvt_pk_bf16_f32 v241, v190, v191
    v_cvt_pk_bf16_f32 v242, v192, v193
    v_cvt_pk_bf16_f32 v243, v194, v195
    v_cvt_pk_bf16_f32 v244, v196, v197
    v_cvt_pk_bf16_f32 v245, v198, v199
    v_cvt_pk_bf16_f32 v246, v200, v201
    v_cvt_pk_bf16_f32 v247, v202, v203
    v_cvt_pk_bf16_f32 v248, v204, v205
    v_cvt_pk_bf16_f32 v249, v206, v207
    v_cvt_pk_bf16_f32 v250, v208, v209
    v_cvt_pk_bf16_f32 v251, v210, v211
    v_cvt_pk_bf16_f32 v252, v212, v213
    v_cvt_pk_bf16_f32 v253, v214, v215
    v_cvt_pk_bf16_f32 v254, v216, v217
    v_cvt_pk_bf16_f32 v255, v218, v219
    v_lshlrev_b32 v56, 3, v41
    v_add_u32 v56, v56, v42
    v_lshlrev_b32 v56, 7, v56
    v_lshl_add_u32 v56, v43, 3, v56
    v_and_b32 v58, 1, v41
    v_lshlrev_b32 v58, 1, v58
    v_lshrrev_b32 v59, 1, v42
    v_or_b32 v58, v58, v59
    v_xor_b32 v58, s3, v58
    v_lshl_add_u32 v56, v58, 5, v56
    v_add_u32 v56, 11776, v56
    v_add_u32 v57, 36864, v56
    v_and_b32 v58, 15, v1
    v_lshlrev_b32 v59, 6, v58
    v_lshl_add_u32 v59, v41, 4, v59
    s_lshl_b32 s66, s73, 2
    s_add_u32 s66, s66, s3
    s_lshl_b32 s66, s66, 9
    s_add_u32 s66, s66, 4194304
    s_waitcnt lgkmcnt(0)
    s_mul_i32 s97, s96, 0x9E3779B1
    s_add_u32 s97, s97, 0x7F4A7C15
    s_mul_i32 s98, s98, 0x85EBCA6D
    s_add_u32 s98, s98, 0x5BD1E995
    s_and_b32 s90, s97, 0xffff
    s_and_b32 s91, s98, 0xffff
    s_and_b32 s92, s97, 0x3ff
    s_and_b32 s93, s98, 0x3ff
    v_mov_b32 v54, s92
    v_mov_b32 v55, s93
    buffer_load_dwordx4 v[96:99], v2, s[28:31], s70 offen nt
    s_add_u32 s70, s70, 1024
    s_cmp_eq_u32 s70, 26624
    s_cselect_b32 s70, 0, s70
    buffer_load_dwordx4 v[100:103], v2, s[28:31], s70 offen nt
    s_add_u32 s70, s70, 1024
    s_cmp_eq_u32 s70, 26624
    s_cselect_b32 s70, 0, s70
    buffer_load_dwordx4 v[104:107], v2, s[28:31], s70 offen nt
    s_add_u32 s70, s70, 1024
    s_cmp_eq_u32 s70, 26624
    s_cselect_b32 s70, 0, s70
    buffer_load_dwordx4 v[108:111], v2, s[28:31], s70 offen nt
    s_add_u32 s70, s70, 1024
    s_cmp_eq_u32 s70, 26624
    s_cselect_b32 s70, 0, s70
    s_barrier
    ds_read_b64_tr_b16 v[148:149], v56 offset:0
    ds_read_b64_tr_b16 v[150:151], v56 offset:512
    ds_read_b64_tr_b16 v[152:153], v56 offset:4096
    ds_read_b64_tr_b16 v[154:155], v56 offset:4608
    ds_read_b64_tr_b16 v[156:157], v56 offset:8192
    ds_read_b64_tr_b16 v[158:159], v56 offset:8704
    ds_read_b64_tr_b16 v[160:161], v56 offset:12288
    ds_read_b64_tr_b16 v[162:163], v56 offset:12800
    ds_read_b64_tr_b16 v[164:165], v56 offset:16384
    ds_read_b64_tr_b16 v[166:167], v56 offset:16896
    ds_read_b64_tr_b16 v[168:169], v56 offset:20480
    ds_read_b64_tr_b16 v[170:171], v56 offset:20992
    s_waitcnt lgkmcnt(10)
    v_mfma_f32_16x16x32_bf16 v[24:27], v[148:151], v[220:223], 0
    ds_read_b64_tr_b16 v[172:173], v56 offset:24576
    ds_read_b64_tr_b16 v[174:175], v56 offset:25088
    s_waitcnt lgkmcnt(10)
    v_mfma_f32_16x16x32_bf16 v[28:31], v[152:155], v[220:223], 0
    ds_read_b64_tr_b16 v[176:177], v56 offset:28672
    ds_read_b64_tr_b16 v[178:179], v56 offset:29184
    s_waitcnt lgkmcnt(10)
    v_mfma_f32_16x16x32_bf16 v[24:27], v[156:159], v[224:227], v[24:27]
    ds_read_b64_tr_b16 v[180:181], v56 offset:32768
    ds_read_b64_tr_b16 v[182:183], v56 offset:33280
    s_waitcnt lgkmcnt(10)
    v_mfma_f32_16x16x32_bf16 v[28:31], v[160:163], v[224:227], v[28:31]
    ds_read_b64_tr_b16 v[184:185], v57 offset:0
    ds_read_b64_tr_b16 v[186:187], v57 offset:512
    s_waitcnt lgkmcnt(10)
    v_mfma_f32_16x16x32_bf16 v[24:27], v[164:167], v[228:231], v[24:27]
    ds_read_b64_tr_b16 v[188:189], v57 offset:4096
    ds_read_b64_tr_b16 v[190:191], v57 offset:4608
    s_waitcnt lgkmcnt(10)
    v_mfma_f32_16x16x32_bf16 v[28:31], v[168:171], v[228:231], v[28:31]
    ds_read_b64_tr_b16 v[192:193], v57 offset:8192
    ds_read_b64_tr_b16 v[194:195], v57 offset:8704
    s_waitcnt lgkmcnt(10)
    v_mfma_f32_16x16x32_bf16 v[24:27], v[172:175], v[232:235], v[24:27]
    ds_read_b64_tr_b16 v[196:197], v57 offset:12288
    ds_read_b64_tr_b16 v[198:199], v57 offset:12800
    s_waitcnt lgkmcnt(10)
    v_mfma_f32_16x16x32_bf16 v[28:31], v[176:179], v[232:235], v[28:31]
    ds_read_b64_tr_b16 v[200:201], v57 offset:16384
    ds_read_b64_tr_b16 v[202:203], v57 offset:16896
    s_waitcnt lgkmcnt(10)
    v_mfma_f32_16x16x32_bf16 v[24:27], v[180:183], v[236:239], v[24:27]
    ds_read_b64_tr_b16 v[204:205], v57 offset:20480
    ds_read_b64_tr_b16 v[206:207], v57 offset:20992
    s_waitcnt lgkmcnt(10)
    v_mfma_f32_16x16x32_bf16 v[28:31], v[184:187], v[236:239], v[28:31]
    ds_read_b64_tr_b16 v[208:209], v57 offset:24576
    ds_read_b64_tr_b16 v[210:211], v57 offset:25088
    s_waitcnt lgkmcnt(10)
    v_mfma_f32_16x16x32_bf16 v[24:27], v[188:191], v[240:243], v[24:27]
    ds_read_b64_tr_b16 v[212:213], v57 offset:28672
    ds_read_b64_tr_b16 v[214:215], v57 offset:29184
    s_waitcnt lgkmcnt(10)
    v_mfma_f32_16x16x32_bf16 v[28:31], v[192:195], v[240:243], v[28:31]
    ds_read_b64_tr_b16 v[216:217], v57 offset:32768
    ds_read_b64_tr_b16 v[218:219], v57 offset:33280
    s_waitcnt lgkmcnt(10)
    v_mfma_f32_16x16x32_bf16 v[24:27], v[196:199], v[244:247], v[24:27]
    s_waitcnt lgkmcnt(8)
    v_mfma_f32_16x16x32_bf16 v[28:31], v[200:203], v[244:247], v[28:31]
    s_waitcnt lgkmcnt(6)
    v_mfma_f32_16x16x32_bf16 v[24:27], v[204:207], v[248:251], v[24:27]
    s_waitcnt lgkmcnt(4)
    v_mfma_f32_16x16x32_bf16 v[28:31], v[208:211], v[248:251], v[28:31]
    s_waitcnt lgkmcnt(2)
    v_mfma_f32_16x16x32_bf16 v[24:27], v[212:215], v[252:255], v[24:27]
    s_waitcnt lgkmcnt(0)
    v_mfma_f32_16x16x32_bf16 v[28:31], v[216:219], v[252:255], v[28:31]
    v_cmp_gt_u32 vcc, 8, v58
    s_nop 6
    v_add_f32_dpp v24, v28, v24 row_ror:8 row_mask:0xf bank_mask:0xf
    v_add_f32_dpp v25, v29, v25 row_ror:8 row_mask:0xf bank_mask:0xf
    v_add_f32_dpp v26, v30, v26 row_ror:8 row_mask:0xf bank_mask:0xf
    v_add_f32_dpp v27, v31, v27 row_ror:8 row_mask:0xf bank_mask:0xf
    v_mov_b32 v29, s97
    v_mov_b32 v31, s98
    v_cvt_pk_bf16_f32 v28, v24, v25
    v_cvt_pk_bf16_f32 v30, v26, v27
    s_mov_b64 exec, vcc
    buffer_store_dwordx4 v[28:31], v59, s[36:39], s66 offen sc1
    s_mov_b64 exec, -1
    buffer_load_dwordx4 v[112:115], v2, s[28:31], s70 offen nt
    s_add_u32 s70, s70, 1024
    s_cmp_eq_u32 s70, 26624
    s_cselect_b32 s70, 0, s70
    buffer_load_dwordx4 v[116:119], v2, s[28:31], s70 offen nt
    s_add_u32 s70, s70, 1024
    s_cmp_eq_u32 s70, 26624
    s_cselect_b32 s70, 0, s70
    buffer_load_dwordx4 v[120:123], v2, s[28:31], s70 offen nt
    s_add_u32 s70, s70, 1024
    s_cmp_eq_u32 s70, 26624
    s_cselect_b32 s70, 0, s70
    buffer_load_dwordx4 v[124:127], v2, s[28:31], s70 offen nt
    s_add_u32 s70, s70, 1024
    s_cmp_eq_u32 s70, 26624
    s_cselect_b32 s70, 0, s70
    buffer_load_dwordx4 v[128:131], v2, s[28:31], s70 offen nt
    s_add_u32 s70, s70, 1024
    s_cmp_eq_u32 s70, 26624
    s_cselect_b32 s70, 0, s70
    buffer_load_dwordx4 v[132:135], v2, s[28:31], s70 offen nt
    s_add_u32 s70, s70, 1024
    s_cmp_eq_u32 s70, 26624
    s_cselect_b32 s70, 0, s70
    buffer_load_dwordx4 v[136:139], v2, s[28:31], s70 offen nt
    s_add_u32 s70, s70, 1024
    s_cmp_eq_u32 s70, 26624
    s_cselect_b32 s70, 0, s70
    buffer_load_dwordx4 v[140:143], v2, s[28:31], s70 offen nt
    s_add_u32 s70, s70, 1024
    s_cmp_eq_u32 s70, 26624
    s_cselect_b32 s70, 0, s70
    s_branch L_common
L_stream_a:
    s_waitcnt vmcnt(3)
    buffer_load_dwordx4 v[112:115], v2, s[28:31], s70 offen nt
    s_add_u32 s70, s70, 1024
    s_cmp_eq_u32 s70, 26624
    s_cselect_b32 s70, 0, s70
    s_cmp_lg_u32 s72, 2
    s_cbranch_scc1 L_nqb
    s_barrier
L_nqb:
    s_waitcnt vmcnt(3)
    buffer_load_dwordx4 v[116:119], v2, s[28:31], s70 offen nt
    s_add_u32 s70, s70, 1024
    s_cmp_eq_u32 s70, 26624
    s_cselect_b32 s70, 0, s70
    s_waitcnt vmcnt(3)
    buffer_load_dwordx4 v[120:123], v2, s[28:31], s70 offen nt
    s_add_u32 s70, s70, 1024
    s_cmp_eq_u32 s70, 26624
    s_cselect_b32 s70, 0, s70
    s_waitcnt vmcnt(3)
    buffer_load_dwordx4 v[124:127], v2, s[28:31], s70 offen nt
    s_add_u32 s70, s70, 1024
    s_cmp_eq_u32 s70, 26624
    s_cselect_b32 s70, 0, s70
    s_waitcnt vmcnt(3)
    buffer_load_dwordx4 v[128:131], v2, s[28:31], s70 offen nt
    s_add_u32 s70, s70, 1024
    s_cmp_eq_u32 s70, 26624
    s_cselect_b32 s70, 0, s70
    s_waitcnt vmcnt(3)
    buffer_load_dwordx4 v[132:135], v2, s[28:31], s70 offen nt
    s_add_u32 s70, s70, 1024
    s_cmp_eq_u32 s70, 26624
    s_cselect_b32 s70, 0, s70
    s_waitcnt vmcnt(3)
    buffer_load_dwordx4 v[136:139], v2, s[28:31], s70 offen nt
    s_add_u32 s70, s70, 1024
    s_cmp_eq_u32 s70, 26624
    s_cselect_b32 s70, 0, s70
    s_waitcnt vmcnt(3)
    buffer_load_dwordx4 v[140:143], v2, s[28:31], s70 offen nt
    s_add_u32 s70, s70, 1024
    s_cmp_eq_u32 s70, 26624
    s_cselect_b32 s70, 0, s70
L_stream_c:
    s_waitcnt lgkmcnt(0)
    s_mul_i32 s97, s96, 0x9E3779B1
    s_add_u32 s97, s97, 0x7F4A7C15
    s_mul_i32 s98, s98, 0x85EBCA6D
    s_add_u32 s98, s98, 0x5BD1E995
    s_and_b32 s90, s97, 0xffff
    s_and_b32 s91, s98, 0xffff
    s_and_b32 s92, s97, 0x3ff
    s_and_b32 s93, s98, 0x3ff
    v_mov_b32 v54, s92
    v_mov_b32 v55, s93
L_common:
    s_waitcnt vmcnt(3)
    buffer_load_dwordx4 v[144:147], v2, s[28:31], s70 offen nt
    s_add_u32 s70, s70, 1024
    s_cmp_eq_u32 s70, 26624
    s_cselect_b32 s70, 0, s70
    s_waitcnt vmcnt(3)
    buffer_load_dwordx4 v[148:151], v2, s[28:31], s70 offen nt
    s_add_u32 s70, s70, 1024
    s_cmp_eq_u32 s70, 26624
    s_cselect_b32 s70, 0, s70
    s_lshl_b32 s66, s3, 10
    s_add_u32 s66, s66, 11776
    s_mul_i32 s68, s3, 9216
    s_add_u32 s68, s68, 0
    s_cmp_lt_u32 s67, 48
    s_cselect_b32 s66, s66, 10752
    s_mov_b32 m0, s66
    s_nop 0
    buffer_load_dwordx4 v39, s[48:51], s68 offen nt lds
    s_waitcnt vmcnt(4)
    buffer_load_dwordx4 v[152:155], v2, s[28:31], s70 offen nt
    s_add_u32 s70, s70, 1024
    s_cmp_eq_u32 s70, 26624
    s_cselect_b32 s70, 0, s70
    s_lshl_b32 s66, s3, 10
    s_add_u32 s66, s66, 19968
    s_mul_i32 s68, s3, 9216
    s_add_u32 s68, s68, 73728
    s_cmp_lt_u32 s67, 48
    s_cselect_b32 s66, s66, 10752
    s_mov_b32 m0, s66
    s_nop 0
    buffer_load_dwordx4 v39, s[48:51], s68 offen nt lds
    s_waitcnt vmcnt(5)
    buffer_load_dwordx4 v[156:159], v2, s[28:31], s70 offen nt
    s_add_u32 s70, s70, 1024
    s_cmp_eq_u32 s70, 26624
    s_cselect_b32 s70, 0, s70
    s_lshl_b32 s66, s3, 10
    s_add_u32 s66, s66, 28160
    s_mul_i32 s68, s3, 9216
    s_add_u32 s68, s68, 147456
    s_cmp_lt_u32 s67, 48
    s_cselect_b32 s66, s66, 10752
    s_mov_b32 m0, s66
    s_nop 0
    buffer_load_dwordx4 v39, s[48:51], s68 offen nt lds
    s_waitcnt vmcnt(6)
    s_mov_b32 s68, 26624
    buffer_load_dwordx4 v[160:163], v2, s[28:31], s68 offen nt
    s_lshl_b32 s66, s3, 10
    s_add_u32 s66, s66, 36352
    s_mul_i32 s68, s3, 9216
    s_add_u32 s68, s68, 221184
    s_cmp_lt_u32 s67, 48
    s_cselect_b32 s66, s66, 10752
    s_mov_b32 m0, s66
    s_nop 0
    buffer_load_dwordx4 v39, s[48:51], s68 offen nt lds
    s_waitcnt vmcnt(7)
    s_mov_b32 s68, 27648
    buffer_load_dwordx4 v[164:167], v2, s[28:31], s68 offen nt
    s_lshl_b32 s66, s3, 10
    s_add_u32 s66, s66, 44544
    s_mul_i32 s68, s3, 9216
    s_add_u32 s68, s68, 128
    s_cmp_lt_u32 s67, 48
    s_cselect_b32 s66, s66, 10752
    s_mov_b32 m0, s66
    s_nop 0
    buffer_load_dwordx4 v39, s[48:51], s68 offen nt lds
    s_waitcnt vmcnt(7)
    s_mov_b32 s68, 28672
    buffer_load_dwordx4 v[168:171], v2, s[28:31], s68 offen nt
    s_lshl_b32 s66, s3, 10
    s_add_u32 s66, s66, 52736
    s_mul_i32 s68, s3, 9216
    s_add_u32 s68, s68, 73856
    s_cmp_lt_u32 s67, 48
    s_cselect_b32 s66, s66, 10752
    s_mov_b32 m0, s66
    s_nop 0
    buffer_load_dwordx4 v39, s[48:51], s68 offen nt lds
    s_waitcnt vmcnt(7)
    s_mov_b32 s68, 29696
    buffer_load_dwordx4 v[172:175], v2, s[28:31], s68 offen nt
    s_lshl_b32 s66, s3, 10
    s_add_u32 s66, s66, 60928
    s_mul_i32 s68, s3, 9216
    s_add_u32 s68, s68, 147584
    s_cmp_lt_u32 s67, 48
    s_cselect_b32 s66, s66, 10752
    s_mov_b32 m0, s66
    s_nop 0
    buffer_load_dwordx4 v39, s[48:51], s68 offen nt lds
    s_waitcnt vmcnt(7)
    s_mov_b32 s68, 30720
    buffer_load_dwordx4 v[176:179], v2, s[28:31], s68 offen nt
    s_lshl_b32 s66, s3, 10
    s_add_u32 s66, s66, 69120
    s_mul_i32 s68, s3, 9216
    s_add_u32 s68, s68, 221312
    s_cmp_lt_u32 s67, 48
    s_cselect_b32 s66, s66, 10752
    s_mov_b32 m0, s66
    s_nop 0
    buffer_load_dwordx4 v39, s[48:51], s68 offen nt lds
    s_waitcnt vmcnt(7)
    s_mov_b32 s68, 31744
    buffer_load_dwordx4 v[180:183], v2, s[28:31], s68 offen nt
    s_lshl_b32 s66, s3, 10
    s_add_u32 s66, s66, 77312
    s_mul_i32 s68, s3, 9216
    s_add_u32 s68, s68, 256
    s_cmp_lt_u32 s67, 48
    s_cselect_b32 s66, s66, 10752
    s_mov_b32 m0, s66
    s_nop 0
    buffer_load_dwordx4 v39, s[48:51], s68 offen nt lds
    s_waitcnt vmcnt(7)
    s_mov_b32 s68, 32768
    buffer_load_dwordx4 v[184:187], v2, s[28:31], s68 offen nt
    s_lshl_b32 s66, s3, 10
    s_add_u32 s66, s66, 85504
    s_mul_i32 s68, s3, 9216
    s_add_u32 s68, s68, 73984
    s_cmp_lt_u32 s67, 48
    s_cselect_b32 s66, s66, 10752
    s_mov_b32 m0, s66
    s_nop 0
    buffer_load_dwordx4 v39, s[48:51], s68 offen nt lds
    s_waitcnt vmcnt(7)
    s_mov_b32 s68, 33792
    buffer_load_dwordx4 v[188:191], v2, s[28:31], s68 offen nt
    s_lshl_b32 s66, s3, 10
    s_add_u32 s66, s66, 93696
    s_mul_i32 s68, s3, 9216
    s_add_u32 s68, s68, 147712
    s_cmp_lt_u32 s67, 48
    s_cselect_b32 s66, s66, 10752
    s_mov_b32 m0, s66
    s_nop 0
    buffer_load_dwordx4 v39, s[48:51], s68 offen nt lds
    s_waitcnt vmcnt(7)
    s_mov_b32 s68, 34816
    buffer_load_dwordx4 v[192:195], v2, s[28:31], s68 offen nt
    s_lshl_b32 s66, s3, 10
    s_add_u32 s66, s66, 101888
    s_mul_i32 s68, s3, 9216
    s_add_u32 s68, s68, 221440
    s_cmp_lt_u32 s67, 48
    s_cselect_b32 s66, s66, 10752
    s_mov_b32 m0, s66
    s_nop 0
    buffer_load_dwordx4 v39, s[48:51], s68 offen nt lds
    s_waitcnt vmcnt(7)
    s_mov_b32 s68, 35840
    buffer_load_dwordx4 v[196:199], v2, s[28:31], s68 offen nt
    s_waitcnt vmcnt(6)
    s_mov_b32 s68, 36864
    buffer_load_dwordx4 v[200:203], v2, s[28:31], s68 offen nt
    s_waitcnt vmcnt(5)
    s_mov_b32 s68, 37888
    buffer_load_dwordx4 v[204:207], v2, s[28:31], s68 offen nt
    s_waitcnt vmcnt(4)
    buffer_load_dwordx4 v[208:211], v2, s[28:31], s70 offen nt
    s_add_u32 s70, s70, 1024
    s_cmp_eq_u32 s70, 26624
    s_cselect_b32 s70, 0, s70
    s_waitcnt vmcnt(3)
    buffer_load_dwordx4 v[212:215], v2, s[28:31], s70 offen nt
    s_add_u32 s70, s70, 1024
    s_cmp_eq_u32 s70, 26624
    s_cselect_b32 s70, 0, s70
    s_waitcnt vmcnt(3)
    buffer_load_dwordx4 v[216:219], v2, s[28:31], s70 offen nt
    s_add_u32 s70, s70, 1024
    s_cmp_eq_u32 s70, 26624
    s_cselect_b32 s70, 0, s70
    s_waitcnt vmcnt(3)
    buffer_load_dwordx4 v[220:223], v2, s[28:31], s70 offen nt
    s_add_u32 s70, s70, 1024
    s_cmp_eq_u32 s70, 26624
    s_cselect_b32 s70, 0, s70
    s_waitcnt vmcnt(3)
    buffer_load_dwordx4 v[224:227], v2, s[28:31], s70 offen nt
    s_add_u32 s70, s70, 1024
    s_cmp_eq_u32 s70, 26624
    s_cselect_b32 s70, 0, s70
    buffer_load_dwordx4 v[44:47], v38, s[36:39], s82 offen sc1
    buffer_load_dwordx4 v[48:51], v38, s[36:39], s82 offen offset:16 sc1
    s_waitcnt vmcnt(5)
    buffer_load_dwordx4 v[228:231], v2, s[28:31], s70 offen nt
    s_add_u32 s70, s70, 1024
    s_cmp_eq_u32 s70, 26624
    s_cselect_b32 s70, 0, s70
    buffer_load_dwordx4 v[232:235], v2, s[28:31], s70 offen nt
    s_add_u32 s70, s70, 1024
    s_cmp_eq_u32 s70, 26624
    s_cselect_b32 s70, 0, s70
    buffer_load_dwordx4 v[236:239], v2, s[28:31], s70 offen nt
    s_add_u32 s70, s70, 1024
    s_cmp_eq_u32 s70, 26624
    s_cselect_b32 s70, 0, s70
    buffer_load_dwordx4 v[240:243], v2, s[28:31], s70 offen nt
    s_add_u32 s70, s70, 1024
    s_cmp_eq_u32 s70, 26624
    s_cselect_b32 s70, 0, s70
    buffer_load_dwordx4 v[244:247], v2, s[28:31], s70 offen nt
    s_add_u32 s70, s70, 1024
    s_cmp_eq_u32 s70, 26624
    s_cselect_b32 s70, 0, s70
    s_waitcnt vmcnt(9)
    buffer_load_dwordx4 v[248:251], v3, s[32:35], s71 offen nt
    s_add_u32 s71, s71, 1024
    s_cmp_eq_u32 s71, 26624
    s_cselect_b32 s71, 0, s71
    s_waitcnt vmcnt(9)
    buffer_load_dwordx4 v[252:255], v3, s[32:35], s71 offen nt
    s_add_u32 s71, s71, 1024
    s_cmp_eq_u32 s71, 26624
    s_cselect_b32 s71, 0, s71
    s_waitcnt vmcnt(9)
    s_waitcnt vmcnt(7)
    s_mov_b32 s80, 0
    s_branch L_qfirst
L_qpoll:
    s_add_u32 s80, s80, 1
    s_cmp_gt_u32 s80, 1000000
    s_cbranch_scc1 L_qpd
    buffer_load_dwordx4 v[44:47], v38, s[36:39], s82 offen sc1
    buffer_load_dwordx4 v[48:51], v38, s[36:39], s82 offen offset:16 sc1
    s_waitcnt vmcnt(0)
L_qfirst:
    v_xor_b32 v45, s97, v45
    v_xor_b32 v47, s98, v47
    v_xor_b32 v49, s97, v49
    v_xor_b32 v51, s98, v51
    v_or3_b32 v45, v45, v47, v49
    v_or_b32 v45, v45, v51
    v_cmp_ne_u32 vcc, 0, v45
    s_cbranch_vccnz L_qpoll
L_qpd:
    v_mov_b32 v4, v44
    v_mov_b32 v5, v46
    v_mov_b32 v6, v48
    v_mov_b32 v7, v50
    s_nop 1
    v_mfma_f32_16x16x32_bf16 v[24:27], v[96:99], v[4:7], 0
    buffer_load_dwordx4 v[96:99], v3, s[32:35], s71 offen nt
    s_add_u32 s71, s71, 1024
    s_cmp_eq_u32 s71, 26624
    s_cselect_b32 s71, 0, s71
    v_mfma_f32_16x16x32_bf16 v[28:31], v[100:103], v[4:7], 0
    s_nop 2
    v_mov_b32_dpp v58, v24 quad_perm:[0,0,0,0] row_mask:0xf bank_mask:0xf
    s_nop 1
    v_add_f32_dpp v58, v25, v58 quad_perm:[1,1,1,1] row_mask:0xf bank_mask:0xf
    s_nop 1
    v_add_f32_dpp v58, v26, v58 quad_perm:[2,2,2,2] row_mask:0xf bank_mask:0xf
    s_nop 1
    v_add_f32_dpp v58, v27, v58 quad_perm:[3,3,3,3] row_mask:0xf bank_mask:0xf
    v_mfma_f32_16x16x32_bf16 v[24:27], v[104:107], v[4:7], 0
    v_mov_b32_dpp v59, v28 quad_perm:[0,0,0,0] row_mask:0xf bank_mask:0xf
    s_nop 1
    v_add_f32_dpp v59, v29, v59 quad_perm:[1,1,1,1] row_mask:0xf bank_mask:0xf
    s_nop 1
    v_add_f32_dpp v59, v30, v59 quad_perm:[2,2,2,2] row_mask:0xf bank_mask:0xf
    s_nop 1
    v_add_f32_dpp v59, v31, v59 quad_perm:[3,3,3,3] row_mask:0xf bank_mask:0xf
    v_cvt_pk_bf16_f32 v32, v58, v59
    v_lshlrev_b32 v58, 16, v32
    v_and_b32 v59, 0xffff0000, v32
    v_mul_f32 v58, s86, v58
    v_mul_f32 v59, s86, v59
    v_cvt_pk_bf16_f32 v32, v58, v59
    v_lshlrev_b32 v58, 16, v32
    v_and_b32 v59, 0xffff0000, v32
    v_max_f32 v34, v58, v59
    v_mfma_f32_16x16x32_bf16 v[28:31], v[108:111], v[4:7], 0
    v_mov_b32_dpp v60, v24 quad_perm:[0,0,0,0] row_mask:0xf bank_mask:0xf
    s_nop 1
    v_add_f32_dpp v60, v25, v60 quad_perm:[1,1,1,1] row_mask:0xf bank_mask:0xf
    s_nop 1
    v_add_f32_dpp v60, v26, v60 quad_perm:[2,2,2,2] row_mask:0xf bank_mask:0xf
    s_nop 1
    v_add_f32_dpp v60, v27, v60 quad_perm:[3,3,3,3] row_mask:0xf bank_mask:0xf
    v_mfma_f32_16x16x32_bf16 v[24:27], v[112:115], v[4:7], 0
    v_mov_b32_dpp v61, v28 quad_perm:[0,0,0,0] row_mask:0xf bank_mask:0xf
    s_nop 1
    v_add_f32_dpp v61, v29, v61 quad_perm:[1,1,1,1] row_mask:0xf bank_mask:0xf
    s_nop 1
    v_add_f32_dpp v61, v30, v61 quad_perm:[2,2,2,2] row_mask:0xf bank_mask:0xf
    s_nop 1
    v_add_f32_dpp v61, v31, v61 quad_perm:[3,3,3,3] row_mask:0xf bank_mask:0xf
    v_cvt_pk_bf16_f32 v32, v60, v61
    v_lshlrev_b32 v60, 16, v32
    v_and_b32 v61, 0xffff0000, v32
    v_mul_f32 v60, s86, v60
    v_mul_f32 v61, s86, v61
    v_cvt_pk_bf16_f32 v32, v60, v61
    v_lshlrev_b32 v60, 16, v32
    v_and_b32 v61, 0xffff0000, v32
    v_max3_f32 v34, v34, v60, v61
    v_mfma_f32_16x16x32_bf16 v[28:31], v[116:119], v[4:7], 0
    v_mov_b32_dpp v62, v24 quad_perm:[0,0,0,0] row_mask:0xf bank_mask:0xf
    s_nop 1
    v_add_f32_dpp v62, v25, v62 quad_perm:[1,1,1,1] row_mask:0xf bank_mask:0xf
    s_nop 1
    v_add_f32_dpp v62, v26, v62 quad_perm:[2,2,2,2] row_mask:0xf bank_mask:0xf
    s_nop 1
    v_add_f32_dpp v62, v27, v62 quad_perm:[3,3,3,3] row_mask:0xf bank_mask:0xf
    v_mfma_f32_16x16x32_bf16 v[24:27], v[120:123], v[4:7], 0
    v_mov_b32_dpp v63, v28 quad_perm:[0,0,0,0] row_mask:0xf bank_mask:0xf
    s_nop 1
    v_add_f32_dpp v63, v29, v63 quad_perm:[1,1,1,1] row_mask:0xf bank_mask:0xf
    s_nop 1
    v_add_f32_dpp v63, v30, v63 quad_perm:[2,2,2,2] row_mask:0xf bank_mask:0xf
    s_nop 1
    v_add_f32_dpp v63, v31, v63 quad_perm:[3,3,3,3] row_mask:0xf bank_mask:0xf
    v_cvt_pk_bf16_f32 v32, v62, v63
    v_lshlrev_b32 v62, 16, v32
    v_and_b32 v63, 0xffff0000, v32
    v_mul_f32 v62, s86, v62
    v_mul_f32 v63, s86, v63
    v_cvt_pk_bf16_f32 v32, v62, v63
    v_lshlrev_b32 v62, 16, v32
    v_and_b32 v63, 0xffff0000, v32
    v_max3_f32 v34, v34, v62, v63
    s_waitcnt vmcnt(7)
    buffer_load_dwordx4 v[100:103], v3, s[32:35], s71 offen nt
    s_add_u32 s71, s71, 1024
    s_cmp_eq_u32 s71, 26624
    s_cselect_b32 s71, 0, s71
    v_mfma_f32_16x16x32_bf16 v[28:31], v[124:127], v[4:7], 0
    v_mov_b32_dpp v64, v24 quad_perm:[0,0,0,0] row_mask:0xf bank_mask:0xf
    s_nop 1
    v_add_f32_dpp v64, v25, v64 quad_perm:[1,1,1,1] row_mask:0xf bank_mask:0xf
    s_nop 1
    v_add_f32_dpp v64, v26, v64 quad_perm:[2,2,2,2] row_mask:0xf bank_mask:0xf
    s_nop 1
    v_add_f32_dpp v64, v27, v64 quad_perm:[3,3,3,3] row_mask:0xf bank_mask:0xf
    v_mfma_f32_16x16x32_bf16 v[24:27], v[128:131], v[4:7], 0
    v_mov_b32_dpp v65, v28 quad_perm:[0,0,0,0] row_mask:0xf bank_mask:0xf
    s_nop 1
    v_add_f32_dpp v65, v29, v65 quad_perm:[1,1,1,1] row_mask:0xf bank_mask:0xf
    s_nop 1
    v_add_f32_dpp v65, v30, v65 quad_perm:[2,2,2,2] row_mask:0xf bank_mask:0xf
    s_nop 1
    v_add_f32_dpp v65, v31, v65 quad_perm:[3,3,3,3] row_mask:0xf bank_mask:0xf
    v_cvt_pk_bf16_f32 v32, v64, v65
    v_lshlrev_b32 v64, 16, v32
    v_and_b32 v65, 0xffff0000, v32
    v_mul_f32 v64, s86, v64
    v_mul_f32 v65, s86, v65
    v_cvt_pk_bf16_f32 v32, v64, v65
    v_lshlrev_b32 v64, 16, v32
    v_and_b32 v65, 0xffff0000, v32
    v_max3_f32 v34, v34, v64, v65
    v_mfma_f32_16x16x32_bf16 v[28:31], v[132:135], v[4:7], 0
    v_mov_b32_dpp v66, v24 quad_perm:[0,0,0,0] row_mask:0xf bank_mask:0xf
    s_nop 1
    v_add_f32_dpp v66, v25, v66 quad_perm:[1,1,1,1] row_mask:0xf bank_mask:0xf
    s_nop 1
    v_add_f32_dpp v66, v26, v66 quad_perm:[2,2,2,2] row_mask:0xf bank_mask:0xf
    s_nop 1
    v_add_f32_dpp v66, v27, v66 quad_perm:[3,3,3,3] row_mask:0xf bank_mask:0xf
    v_mfma_f32_16x16x32_bf16 v[24:27], v[136:139], v[4:7], 0
    v_mov_b32_dpp v67, v28 quad_perm:[0,0,0,0] row_mask:0xf bank_mask:0xf
    s_nop 1
    v_add_f32_dpp v67, v29, v67 quad_perm:[1,1,1,1] row_mask:0xf bank_mask:0xf
    s_nop 1
    v_add_f32_dpp v67, v30, v67 quad_perm:[2,2,2,2] row_mask:0xf bank_mask:0xf
    s_nop 1
    v_add_f32_dpp v67, v31, v67 quad_perm:[3,3,3,3] row_mask:0xf bank_mask:0xf
    v_cvt_pk_bf16_f32 v32, v66, v67
    v_lshlrev_b32 v66, 16, v32
    v_and_b32 v67, 0xffff0000, v32
    v_mul_f32 v66, s86, v66
    v_mul_f32 v67, s86, v67
    v_cvt_pk_bf16_f32 v32, v66, v67
    v_lshlrev_b32 v66, 16, v32
    v_and_b32 v67, 0xffff0000, v32
    v_max3_f32 v34, v34, v66, v67
    v_mfma_f32_16x16x32_bf16 v[28:31], v[140:143], v[4:7], 0
    v_mov_b32_dpp v68, v24 quad_perm:[0,0,0,0] row_mask:0xf bank_mask:0xf
    s_nop 1
    v_add_f32_dpp v68, v25, v68 quad_perm:[1,1,1,1] row_mask:0xf bank_mask:0xf
    s_nop 1
    v_add_f32_dpp v68, v26, v68 quad_perm:[2,2,2,2] row_mask:0xf bank_mask:0xf
    s_nop 1
    v_add_f32_dpp v68, v27, v68 quad_perm:[3,3,3,3] row_mask:0xf bank_mask:0xf
    v_mfma_f32_16x16x32_bf16 v[24:27], v[144:147], v[4:7], 0
    v_mov_b32_dpp v69, v28 quad_perm:[0,0,0,0] row_mask:0xf bank_mask:0xf
    s_nop 1
    v_add_f32_dpp v69, v29, v69 quad_perm:[1,1,1,1] row_mask:0xf bank_mask:0xf
    s_nop 1
    v_add_f32_dpp v69, v30, v69 quad_perm:[2,2,2,2] row_mask:0xf bank_mask:0xf
    s_nop 1
    v_add_f32_dpp v69, v31, v69 quad_perm:[3,3,3,3] row_mask:0xf bank_mask:0xf
    v_cvt_pk_bf16_f32 v32, v68, v69
    v_lshlrev_b32 v68, 16, v32
    v_and_b32 v69, 0xffff0000, v32
    v_mul_f32 v68, s86, v68
    v_mul_f32 v69, s86, v69
    v_cvt_pk_bf16_f32 v32, v68, v69
    v_lshlrev_b32 v68, 16, v32
    v_and_b32 v69, 0xffff0000, v32
    v_max3_f32 v34, v34, v68, v69
    s_waitcnt vmcnt(7)
    buffer_load_dwordx4 v[104:107], v3, s[32:35], s71 offen nt
    s_add_u32 s71, s71, 1024
    s_cmp_eq_u32 s71, 26624
    s_cselect_b32 s71, 0, s71
    v_mfma_f32_16x16x32_bf16 v[28:31], v[148:151], v[4:7], 0
    v_mov_b32_dpp v70, v24 quad_perm:[0,0,0,0] row_mask:0xf bank_mask:0xf
    s_nop 1
    v_add_f32_dpp v70, v25, v70 quad_perm:[1,1,1,1] row_mask:0xf bank_mask:0xf
    s_nop 1
    v_add_f32_dpp v70, v26, v70 quad_perm:[2,2,2,2] row_mask:0xf bank_mask:0xf
    s_nop 1
    v_add_f32_dpp v70, v27, v70 quad_perm:[3,3,3,3] row_mask:0xf bank_mask:0xf
    v_mfma_f32_16x16x32_bf16 v[24:27], v[152:155], v[4:7], 0
    v_mov_b32_dpp v71, v28 quad_perm:[0,0,0,0] row_mask:0xf bank_mask:0xf
    s_nop 1
    v_add_f32_dpp v71, v29, v71 quad_perm:[1,1,1,1] row_mask:0xf bank_mask:0xf
    s_nop 1
    v_add_f32_dpp v71, v30, v71 quad_perm:[2,2,2,2] row_mask:0xf bank_mask:0xf
    s_nop 1
    v_add_f32_dpp v71, v31, v71 quad_perm:[3,3,3,3] row_mask:0xf bank_mask:0xf
    v_cvt_pk_bf16_f32 v32, v70, v71
    v_lshlrev_b32 v70, 16, v32
    v_and_b32 v71, 0xffff0000, v32
    v_mul_f32 v70, s86, v70
    v_mul_f32 v71, s86, v71
    v_cvt_pk_bf16_f32 v32, v70, v71
    v_lshlrev_b32 v70, 16, v32
    v_and_b32 v71, 0xffff0000, v32
    v_max3_f32 v34, v34, v70, v71
    v_mfma_f32_16x16x32_bf16 v[28:31], v[156:159], v[4:7], 0
    v_mov_b32_dpp v72, v24 quad_perm:[0,0,0,0] row_mask:0xf bank_mask:0xf
    s_nop 1
    v_add_f32_dpp v72, v25, v72 quad_perm:[1,1,1,1] row_mask:0xf bank_mask:0xf
    s_nop 1
    v_add_f32_dpp v72, v26, v72 quad_perm:[2,2,2,2] row_mask:0xf bank_mask:0xf
    s_nop 1
    v_add_f32_dpp v72, v27, v72 quad_perm:[3,3,3,3] row_mask:0xf bank_mask:0xf
    v_mfma_f32_16x16x32_bf16 v[24:27], v[160:163], v[4:7], 0
    v_mov_b32_dpp v73, v28 quad_perm:[0,0,0,0] row_mask:0xf bank_mask:0xf
    s_nop 1
    v_add_f32_dpp v73, v29, v73 quad_perm:[1,1,1,1] row_mask:0xf bank_mask:0xf
    s_nop 1
    v_add_f32_dpp v73, v30, v73 quad_perm:[2,2,2,2] row_mask:0xf bank_mask:0xf
    s_nop 1
    v_add_f32_dpp v73, v31, v73 quad_perm:[3,3,3,3] row_mask:0xf bank_mask:0xf
    v_cvt_pk_bf16_f32 v32, v72, v73
    v_lshlrev_b32 v72, 16, v32
    v_and_b32 v73, 0xffff0000, v32
    v_mul_f32 v72, s86, v72
    v_mul_f32 v73, s86, v73
    v_cvt_pk_bf16_f32 v32, v72, v73
    v_lshlrev_b32 v72, 16, v32
    v_and_b32 v73, 0xffff0000, v32
    v_max3_f32 v34, v34, v72, v73
    v_mfma_f32_16x16x32_bf16 v[28:31], v[164:167], v[4:7], 0
    v_mov_b32_dpp v74, v24 quad_perm:[0,0,0,0] row_mask:0xf bank_mask:0xf
    s_nop 1
    v_add_f32_dpp v74, v25, v74 quad_perm:[1,1,1,1] row_mask:0xf bank_mask:0xf
    s_nop 1
    v_add_f32_dpp v74, v26, v74 quad_perm:[2,2,2,2] row_mask:0xf bank_mask:0xf
    s_nop 1
    v_add_f32_dpp v74, v27, v74 quad_perm:[3,3,3,3] row_mask:0xf bank_mask:0xf
    v_mfma_f32_16x16x32_bf16 v[24:27], v[168:171], v[4:7], 0
    v_mov_b32_dpp v75, v28 quad_perm:[0,0,0,0] row_mask:0xf bank_mask:0xf
    s_nop 1
    v_add_f32_dpp v75, v29, v75 quad_perm:[1,1,1,1] row_mask:0xf bank_mask:0xf
    s_nop 1
    v_add_f32_dpp v75, v30, v75 quad_perm:[2,2,2,2] row_mask:0xf bank_mask:0xf
    s_nop 1
    v_add_f32_dpp v75, v31, v75 quad_perm:[3,3,3,3] row_mask:0xf bank_mask:0xf
    v_cvt_pk_bf16_f32 v32, v74, v75
    v_lshlrev_b32 v74, 16, v32
    v_and_b32 v75, 0xffff0000, v32
    v_mul_f32 v74, s86, v74
    v_mul_f32 v75, s86, v75
    v_cvt_pk_bf16_f32 v32, v74, v75
    v_lshlrev_b32 v74, 16, v32
    v_and_b32 v75, 0xffff0000, v32
    s_cmp_gt_u32 s85, 26
    s_cselect_b32 s66, 0, 0xff800000
    v_add_f32 v74, s66, v74
    s_cmp_gt_u32 s85, 27
    s_cselect_b32 s66, 0, 0xff800000
    v_add_f32 v75, s66, v75
    v_max3_f32 v34, v34, v74, v75
    s_waitcnt vmcnt(7)
    buffer_load_dwordx4 v[108:111], v3, s[32:35], s71 offen nt
    s_add_u32 s71, s71, 1024
    s_cmp_eq_u32 s71, 26624
    s_cselect_b32 s71, 0, s71
    v_mfma_f32_16x16x32_bf16 v[28:31], v[172:175], v[4:7], 0
    v_mov_b32_dpp v76, v24 quad_perm:[0,0,0,0] row_mask:0xf bank_mask:0xf
    s_nop 1
    v_add_f32_dpp v76, v25, v76 quad_perm:[1,1,1,1] row_mask:0xf bank_mask:0xf
    s_nop 1
    v_add_f32_dpp v76, v26, v76 quad_perm:[2,2,2,2] row_mask:0xf bank_mask:0xf
    s_nop 1
    v_add_f32_dpp v76, v27, v76 quad_perm:[3,3,3,3] row_mask:0xf bank_mask:0xf
    v_mfma_f32_16x16x32_bf16 v[24:27], v[176:179], v[4:7], 0
    v_mov_b32_dpp v77, v28 quad_perm:[0,0,0,0] row_mask:0xf bank_mask:0xf
    s_nop 1
    v_add_f32_dpp v77, v29, v77 quad_perm:[1,1,1,1] row_mask:0xf bank_mask:0xf
    s_nop 1
    v_add_f32_dpp v77, v30, v77 quad_perm:[2,2,2,2] row_mask:0xf bank_mask:0xf
    s_nop 1
    v_add_f32_dpp v77, v31, v77 quad_perm:[3,3,3,3] row_mask:0xf bank_mask:0xf
    v_cvt_pk_bf16_f32 v32, v76, v77
    v_lshlrev_b32 v76, 16, v32
    v_and_b32 v77, 0xffff0000, v32
    v_mul_f32 v76, s86, v76
    v_mul_f32 v77, s86, v77
    v_cvt_pk_bf16_f32 v32, v76, v77
    v_lshlrev_b32 v76, 16, v32
    v_and_b32 v77, 0xffff0000, v32
    s_cmp_gt_u32 s85, 28
    s_cselect_b32 s66, 0, 0xff800000
    v_add_f32 v76, s66, v76
    s_cmp_gt_u32 s85, 29
    s_cselect_b32 s66, 0, 0xff800000
    v_add_f32 v77, s66, v77
    v_max3_f32 v34, v34, v76, v77
    v_mfma_f32_16x16x32_bf16 v[28:31], v[180:183], v[4:7], 0
    v_mov_b32_dpp v78, v24 quad_perm:[0,0,0,0] row_mask:0xf bank_mask:0xf
    s_nop 1
    v_add_f32_dpp v78, v25, v78 quad_perm:[1,1,1,1] row_mask:0xf bank_mask:0xf
    s_nop 1
    v_add_f32_dpp v78, v26, v78 quad_perm:[2,2,2,2] row_mask:0xf bank_mask:0xf
    s_nop 1
    v_add_f32_dpp v78, v27, v78 quad_perm:[3,3,3,3] row_mask:0xf bank_mask:0xf
    v_mfma_f32_16x16x32_bf16 v[24:27], v[184:187], v[4:7], 0
    v_mov_b32_dpp v79, v28 quad_perm:[0,0,0,0] row_mask:0xf bank_mask:0xf
    s_nop 1
    v_add_f32_dpp v79, v29, v79 quad_perm:[1,1,1,1] row_mask:0xf bank_mask:0xf
    s_nop 1
    v_add_f32_dpp v79, v30, v79 quad_perm:[2,2,2,2] row_mask:0xf bank_mask:0xf
    s_nop 1
    v_add_f32_dpp v79, v31, v79 quad_perm:[3,3,3,3] row_mask:0xf bank_mask:0xf
    v_cvt_pk_bf16_f32 v32, v78, v79
    v_lshlrev_b32 v78, 16, v32
    v_and_b32 v79, 0xffff0000, v32
    v_mul_f32 v78, s86, v78
    v_mul_f32 v79, s86, v79
    v_cvt_pk_bf16_f32 v32, v78, v79
    v_lshlrev_b32 v78, 16, v32
    v_and_b32 v79, 0xffff0000, v32
    s_cmp_gt_u32 s85, 30
    s_cselect_b32 s66, 0, 0xff800000
    v_add_f32 v78, s66, v78
    s_cmp_gt_u32 s85, 31
    s_cselect_b32 s66, 0, 0xff800000
    v_add_f32 v79, s66, v79
    v_max3_f32 v34, v34, v78, v79
    v_mfma_f32_16x16x32_bf16 v[28:31], v[188:191], v[4:7], 0
    v_mov_b32_dpp v80, v24 quad_perm:[0,0,0,0] row_mask:0xf bank_mask:0xf
    s_nop 1
    v_add_f32_dpp v80, v25, v80 quad_perm:[1,1,1,1] row_mask:0xf bank_mask:0xf
    s_nop 1
    v_add_f32_dpp v80, v26, v80 quad_perm:[2,2,2,2] row_mask:0xf bank_mask:0xf
    s_nop 1
    v_add_f32_dpp v80, v27, v80 quad_perm:[3,3,3,3] row_mask:0xf bank_mask:0xf
    v_mfma_f32_16x16x32_bf16 v[24:27], v[192:195], v[4:7], 0
    v_mov_b32_dpp v81, v28 quad_perm:[0,0,0,0] row_mask:0xf bank_mask:0xf
    s_nop 1
    v_add_f32_dpp v81, v29, v81 quad_perm:[1,1,1,1] row_mask:0xf bank_mask:0xf
    s_nop 1
    v_add_f32_dpp v81, v30, v81 quad_perm:[2,2,2,2] row_mask:0xf bank_mask:0xf
    s_nop 1
    v_add_f32_dpp v81, v31, v81 quad_perm:[3,3,3,3] row_mask:0xf bank_mask:0xf
    v_cvt_pk_bf16_f32 v32, v80, v81
    v_lshlrev_b32 v80, 16, v32
    v_and_b32 v81, 0xffff0000, v32
    v_mul_f32 v80, s86, v80
    v_mul_f32 v81, s86, v81
    v_cvt_pk_bf16_f32 v32, v80, v81
    v_lshlrev_b32 v80, 16, v32
    v_and_b32 v81, 0xffff0000, v32
    s_cmp_gt_u32 s85, 32
    s_cselect_b32 s66, 0, 0xff800000
    v_add_f32 v80, s66, v80
    s_cmp_gt_u32 s85, 33
    s_cselect_b32 s66, 0, 0xff800000
    v_add_f32 v81, s66, v81
    v_max3_f32 v34, v34, v80, v81
    s_waitcnt vmcnt(7)
    buffer_load_dwordx4 v[112:115], v3, s[32:35], s71 offen nt
    s_add_u32 s71, s71, 1024
    s_cmp_eq_u32 s71, 26624
    s_cselect_b32 s71, 0, s71
    v_mfma_f32_16x16x32_bf16 v[28:31], v[196:199], v[4:7], 0
    v_mov_b32_dpp v82, v24 quad_perm:[0,0,0,0] row_mask:0xf bank_mask:0xf
    s_nop 1
    v_add_f32_dpp v82, v25, v82 quad_perm:[1,1,1,1] row_mask:0xf bank_mask:0xf
    s_nop 1
    v_add_f32_dpp v82, v26, v82 quad_perm:[2,2,2,2] row_mask:0xf bank_mask:0xf
    s_nop 1
    v_add_f32_dpp v82, v27, v82 quad_perm:[3,3,3,3] row_mask:0xf bank_mask:0xf
    v_mfma_f32_16x16x32_bf16 v[24:27], v[200:203], v[4:7], 0
    v_mov_b32_dpp v83, v28 quad_perm:[0,0,0,0] row_mask:0xf bank_mask:0xf
    s_nop 1
    v_add_f32_dpp v83, v29, v83 quad_perm:[1,1,1,1] row_mask:0xf bank_mask:0xf
    s_nop 1
    v_add_f32_dpp v83, v30, v83 quad_perm:[2,2,2,2] row_mask:0xf bank_mask:0xf
    s_nop 1
    v_add_f32_dpp v83, v31, v83 quad_perm:[3,3,3,3] row_mask:0xf bank_mask:0xf
    v_cvt_pk_bf16_f32 v32, v82, v83
    v_lshlrev_b32 v82, 16, v32
    v_and_b32 v83, 0xffff0000, v32
    v_mul_f32 v82, s86, v82
    v_mul_f32 v83, s86, v83
    v_cvt_pk_bf16_f32 v32, v82, v83
    v_lshlrev_b32 v82, 16, v32
    v_and_b32 v83, 0xffff0000, v32
    s_cmp_gt_u32 s85, 34
    s_cselect_b32 s66, 0, 0xff800000
    v_add_f32 v82, s66, v82
    s_cmp_gt_u32 s85, 35
    s_cselect_b32 s66, 0, 0xff800000
    v_add_f32 v83, s66, v83
    v_max3_f32 v34, v34, v82, v83
    v_mfma_f32_16x16x32_bf16 v[28:31], v[204:207], v[4:7], 0
    v_mov_b32_dpp v84, v24 quad_perm:[0,0,0,0] row_mask:0xf bank_mask:0xf
    s_nop 1
    v_add_f32_dpp v84, v25, v84 quad_perm:[1,1,1,1] row_mask:0xf bank_mask:0xf
    s_nop 1
    v_add_f32_dpp v84, v26, v84 quad_perm:[2,2,2,2] row_mask:0xf bank_mask:0xf
    s_nop 1
    v_add_f32_dpp v84, v27, v84 quad_perm:[3,3,3,3] row_mask:0xf bank_mask:0xf
    v_mfma_f32_16x16x32_bf16 v[24:27], v[208:211], v[4:7], 0
    v_mov_b32_dpp v85, v28 quad_perm:[0,0,0,0] row_mask:0xf bank_mask:0xf
    s_nop 1
    v_add_f32_dpp v85, v29, v85 quad_perm:[1,1,1,1] row_mask:0xf bank_mask:0xf
    s_nop 1
    v_add_f32_dpp v85, v30, v85 quad_perm:[2,2,2,2] row_mask:0xf bank_mask:0xf
    s_nop 1
    v_add_f32_dpp v85, v31, v85 quad_perm:[3,3,3,3] row_mask:0xf bank_mask:0xf
    v_cvt_pk_bf16_f32 v32, v84, v85
    v_lshlrev_b32 v84, 16, v32
    v_and_b32 v85, 0xffff0000, v32
    v_mul_f32 v84, s86, v84
    v_mul_f32 v85, s86, v85
    v_cvt_pk_bf16_f32 v32, v84, v85
    v_lshlrev_b32 v84, 16, v32
    v_and_b32 v85, 0xffff0000, v32
    s_cmp_gt_u32 s85, 36
    s_cselect_b32 s66, 0, 0xff800000
    v_add_f32 v84, s66, v84
    s_cmp_gt_u32 s85, 37
    s_cselect_b32 s66, 0, 0xff800000
    v_add_f32 v85, s66, v85
    v_max3_f32 v34, v34, v84, v85
    v_mfma_f32_16x16x32_bf16 v[28:31], v[212:215], v[4:7], 0
    v_mov_b32_dpp v86, v24 quad_perm:[0,0,0,0] row_mask:0xf bank_mask:0xf
    s_nop 1
    v_add_f32_dpp v86, v25, v86 quad_perm:[1,1,1,1] row_mask:0xf bank_mask:0xf
    s_nop 1
    v_add_f32_dpp v86, v26, v86 quad_perm:[2,2,2,2] row_mask:0xf bank_mask:0xf
    s_nop 1
    v_add_f32_dpp v86, v27, v86 quad_perm:[3,3,3,3] row_mask:0xf bank_mask:0xf
    v_mfma_f32_16x16x32_bf16 v[24:27], v[216:219], v[4:7], 0
    v_mov_b32_dpp v87, v28 quad_perm:[0,0,0,0] row_mask:0xf bank_mask:0xf
    s_nop 1
    v_add_f32_dpp v87, v29, v87 quad_perm:[1,1,1,1] row_mask:0xf bank_mask:0xf
    s_nop 1
    v_add_f32_dpp v87, v30, v87 quad_perm:[2,2,2,2] row_mask:0xf bank_mask:0xf
    s_nop 1
    v_add_f32_dpp v87, v31, v87 quad_perm:[3,3,3,3] row_mask:0xf bank_mask:0xf
    v_cvt_pk_bf16_f32 v32, v86, v87
    v_lshlrev_b32 v86, 16, v32
    v_and_b32 v87, 0xffff0000, v32
    v_mul_f32 v86, s86, v86
    v_mul_f32 v87, s86, v87
    v_cvt_pk_bf16_f32 v32, v86, v87
    v_lshlrev_b32 v86, 16, v32
    v_and_b32 v87, 0xffff0000, v32
    v_max3_f32 v34, v34, v86, v87
    s_waitcnt vmcnt(7)
    buffer_load_dwordx4 v[116:119], v3, s[32:35], s71 offen nt
    s_add_u32 s71, s71, 1024
    s_cmp_eq_u32 s71, 26624
    s_cselect_b32 s71, 0, s71
    v_mfma_f32_16x16x32_bf16 v[28:31], v[220:223], v[4:7], 0
    v_mov_b32_dpp v88, v24 quad_perm:[0,0,0,0] row_mask:0xf bank_mask:0xf
    s_nop 1
    v_add_f32_dpp v88, v25, v88 quad_perm:[1,1,1,1] row_mask:0xf bank_mask:0xf
    s_nop 1
    v_add_f32_dpp v88, v26, v88 quad_perm:[2,2,2,2] row_mask:0xf bank_mask:0xf
    s_nop 1
    v_add_f32_dpp v88, v27, v88 quad_perm:[3,3,3,3] row_mask:0xf bank_mask:0xf
    v_mfma_f32_16x16x32_bf16 v[24:27], v[224:227], v[4:7], 0
    v_mov_b32_dpp v89, v28 quad_perm:[0,0,0,0] row_mask:0xf bank_mask:0xf
    s_nop 1
    v_add_f32_dpp v89, v29, v89 quad_perm:[1,1,1,1] row_mask:0xf bank_mask:0xf
    s_nop 1
    v_add_f32_dpp v89, v30, v89 quad_perm:[2,2,2,2] row_mask:0xf bank_mask:0xf
    s_nop 1
    v_add_f32_dpp v89, v31, v89 quad_perm:[3,3,3,3] row_mask:0xf bank_mask:0xf
    v_cvt_pk_bf16_f32 v32, v88, v89
    v_lshlrev_b32 v88, 16, v32
    v_and_b32 v89, 0xffff0000, v32
    v_mul_f32 v88, s86, v88
    v_mul_f32 v89, s86, v89
    v_cvt_pk_bf16_f32 v32, v88, v89
    v_lshlrev_b32 v88, 16, v32
    v_and_b32 v89, 0xffff0000, v32
    v_max3_f32 v34, v34, v88, v89
    v_mfma_f32_16x16x32_bf16 v[28:31], v[228:231], v[4:7], 0
    v_mov_b32_dpp v90, v24 quad_perm:[0,0,0,0] row_mask:0xf bank_mask:0xf
    s_nop 1
    v_add_f32_dpp v90, v25, v90 quad_perm:[1,1,1,1] row_mask:0xf bank_mask:0xf
    s_nop 1
    v_add_f32_dpp v90, v26, v90 quad_perm:[2,2,2,2] row_mask:0xf bank_mask:0xf
    s_nop 1
    v_add_f32_dpp v90, v27, v90 quad_perm:[3,3,3,3] row_mask:0xf bank_mask:0xf
    v_mfma_f32_16x16x32_bf16 v[24:27], v[232:235], v[4:7], 0
    v_mov_b32_dpp v91, v28 quad_perm:[0,0,0,0] row_mask:0xf bank_mask:0xf
    s_nop 1
    v_add_f32_dpp v91, v29, v91 quad_perm:[1,1,1,1] row_mask:0xf bank_mask:0xf
    s_nop 1
    v_add_f32_dpp v91, v30, v91 quad_perm:[2,2,2,2] row_mask:0xf bank_mask:0xf
    s_nop 1
    v_add_f32_dpp v91, v31, v91 quad_perm:[3,3,3,3] row_mask:0xf bank_mask:0xf
    v_cvt_pk_bf16_f32 v32, v90, v91
    v_lshlrev_b32 v90, 16, v32
    v_and_b32 v91, 0xffff0000, v32
    v_mul_f32 v90, s86, v90
    v_mul_f32 v91, s86, v91
    v_cvt_pk_bf16_f32 v32, v90, v91
    v_lshlrev_b32 v90, 16, v32
    v_and_b32 v91, 0xffff0000, v32
    v_max3_f32 v34, v34, v90, v91
    v_mfma_f32_16x16x32_bf16 v[28:31], v[236:239], v[4:7], 0
    v_mov_b32_dpp v92, v24 quad_perm:[0,0,0,0] row_mask:0xf bank_mask:0xf
    s_nop 1
    v_add_f32_dpp v92, v25, v92 quad_perm:[1,1,1,1] row_mask:0xf bank_mask:0xf
    s_nop 1
    v_add_f32_dpp v92, v26, v92 quad_perm:[2,2,2,2] row_mask:0xf bank_mask:0xf
    s_nop 1
    v_add_f32_dpp v92, v27, v92 quad_perm:[3,3,3,3] row_mask:0xf bank_mask:0xf
    v_mfma_f32_16x16x32_bf16 v[24:27], v[240:243], v[4:7], 0
    v_mov_b32_dpp v93, v28 quad_perm:[0,0,0,0] row_mask:0xf bank_mask:0xf
    s_nop 1
    v_add_f32_dpp v93, v29, v93 quad_perm:[1,1,1,1] row_mask:0xf bank_mask:0xf
    s_nop 1
    v_add_f32_dpp v93, v30, v93 quad_perm:[2,2,2,2] row_mask:0xf bank_mask:0xf
    s_nop 1
    v_add_f32_dpp v93, v31, v93 quad_perm:[3,3,3,3] row_mask:0xf bank_mask:0xf
    v_cvt_pk_bf16_f32 v32, v92, v93
    v_lshlrev_b32 v92, 16, v32
    v_and_b32 v93, 0xffff0000, v32
    v_mul_f32 v92, s86, v92
    v_mul_f32 v93, s86, v93
    v_cvt_pk_bf16_f32 v32, v92, v93
    v_lshlrev_b32 v92, 16, v32
    v_and_b32 v93, 0xffff0000, v32
    v_max3_f32 v34, v34, v92, v93
    s_waitcnt vmcnt(7)
    buffer_load_dwordx4 v[120:123], v3, s[32:35], s71 offen nt
    s_add_u32 s71, s71, 1024
    s_cmp_eq_u32 s71, 26624
    s_cselect_b32 s71, 0, s71
    v_mfma_f32_16x16x32_bf16 v[28:31], v[244:247], v[4:7], 0
    v_mov_b32_dpp v94, v24 quad_perm:[0,0,0,0] row_mask:0xf bank_mask:0xf
    s_nop 1
    v_add_f32_dpp v94, v25, v94 quad_perm:[1,1,1,1] row_mask:0xf bank_mask:0xf
    s_nop 1
    v_add_f32_dpp v94, v26, v94 quad_perm:[2,2,2,2] row_mask:0xf bank_mask:0xf
    s_nop 1
    v_add_f32_dpp v94, v27, v94 quad_perm:[3,3,3,3] row_mask:0xf bank_mask:0xf
    v_mov_b32_dpp v95, v28 quad_perm:[0,0,0,0] row_mask:0xf bank_mask:0xf
    s_nop 1
    v_add_f32_dpp v95, v29, v95 quad_perm:[1,1,1,1] row_mask:0xf bank_mask:0xf
    s_nop 1
    v_add_f32_dpp v95, v30, v95 quad_perm:[2,2,2,2] row_mask:0xf bank_mask:0xf
    s_nop 1
    v_add_f32_dpp v95, v31, v95 quad_perm:[3,3,3,3] row_mask:0xf bank_mask:0xf
    v_cvt_pk_bf16_f32 v32, v94, v95
    v_lshlrev_b32 v94, 16, v32
    v_and_b32 v95, 0xffff0000, v32
    v_mul_f32 v94, s86, v94
    v_mul_f32 v95, s86, v95
    v_cvt_pk_bf16_f32 v32, v94, v95
    v_lshlrev_b32 v94, 16, v32
    v_and_b32 v95, 0xffff0000, v32
    v_max3_f32 v34, v34, v94, v95
    v_mov_b32 v35, v34
    s_nop 1
    v_permlane16_swap_b32 v34, v35
    v_max_f32 v34, v34, v35
    v_mov_b32 v35, v34
    s_nop 1
    v_permlane32_swap_b32 v34, v35
    v_max_f32 v34, v34, v35
    v_mul_f32 v36, s87, v34
    v_mov_b32 v37, 0
    v_fma_f32 v58, v58, s87, -v36
    v_fma_f32 v59, v59, s87, -v36
    v_fma_f32 v60, v60, s87, -v36
    v_fma_f32 v61, v61, s87, -v36
    v_fma_f32 v62, v62, s87, -v36
    v_fma_f32 v63, v63, s87, -v36
    v_fma_f32 v64, v64, s87, -v36
    v_fma_f32 v65, v65, s87, -v36
    v_exp_f32 v58, v58
    v_exp_f32 v59, v59
    v_exp_f32 v60, v60
    v_exp_f32 v61, v61
    v_exp_f32 v62, v62
    v_exp_f32 v63, v63
    v_exp_f32 v64, v64
    v_exp_f32 v65, v65
    v_add_f32 v37, v37, v58
    v_cvt_pk_bf16_f32 v58, v58, v58
    v_add_f32 v37, v37, v59
    v_cvt_pk_bf16_f32 v59, v59, v59
    v_add_f32 v37, v37, v60
    v_cvt_pk_bf16_f32 v60, v60, v60
    v_add_f32 v37, v37, v61
    v_cvt_pk_bf16_f32 v61, v61, v61
    v_add_f32 v37, v37, v62
    v_cvt_pk_bf16_f32 v62, v62, v62
    v_add_f32 v37, v37, v63
    v_cvt_pk_bf16_f32 v63, v63, v63
    v_add_f32 v37, v37, v64
    v_cvt_pk_bf16_f32 v64, v64, v64
    v_add_f32 v37, v37, v65
    v_cvt_pk_bf16_f32 v65, v65, v65
    v_fma_f32 v66, v66, s87, -v36
    v_fma_f32 v67, v67, s87, -v36
    v_fma_f32 v68, v68, s87, -v36
    v_fma_f32 v69, v69, s87, -v36
    v_fma_f32 v70, v70, s87, -v36
    v_fma_f32 v71, v71, s87, -v36
    v_fma_f32 v72, v72, s87, -v36
    v_fma_f32 v73, v73, s87, -v36
    v_exp_f32 v66, v66
    v_exp_f32 v67, v67
    v_exp_f32 v68, v68
    v_exp_f32 v69, v69
    v_exp_f32 v70, v70
    v_exp_f32 v71, v71
    v_exp_f32 v72, v72
    v_exp_f32 v73, v73
    v_add_f32 v37, v37, v66
    v_cvt_pk_bf16_f32 v66, v66, v66
    v_add_f32 v37, v37, v67
    v_cvt_pk_bf16_f32 v67, v67, v67
    v_add_f32 v37, v37, v68
    v_cvt_pk_bf16_f32 v68, v68, v68
    v_add_f32 v37, v37, v69
    v_cvt_pk_bf16_f32 v69, v69, v69
    v_add_f32 v37, v37, v70
    v_cvt_pk_bf16_f32 v70, v70, v70
    v_add_f32 v37, v37, v71
    v_cvt_pk_bf16_f32 v71, v71, v71
    v_add_f32 v37, v37, v72
    v_cvt_pk_bf16_f32 v72, v72, v72
    v_add_f32 v37, v37, v73
    v_cvt_pk_bf16_f32 v73, v73, v73
    s_waitcnt vmcnt(7)
    buffer_load_dwordx4 v[124:127], v3, s[32:35], s71 offen nt
    s_add_u32 s71, s71, 1024
    s_cmp_eq_u32 s71, 26624
    s_cselect_b32 s71, 0, s71
    v_fma_f32 v74, v74, s87, -v36
    v_fma_f32 v75, v75, s87, -v36
    v_fma_f32 v76, v76, s87, -v36
    v_fma_f32 v77, v77, s87, -v36
    v_fma_f32 v78, v78, s87, -v36
    v_fma_f32 v79, v79, s87, -v36
    v_fma_f32 v80, v80, s87, -v36
    v_fma_f32 v81, v81, s87, -v36
    v_exp_f32 v74, v74
    v_exp_f32 v75, v75
    v_exp_f32 v76, v76
    v_exp_f32 v77, v77
    v_exp_f32 v78, v78
    v_exp_f32 v79, v79
    v_exp_f32 v80, v80
    v_exp_f32 v81, v81
    v_add_f32 v37, v37, v74
    v_cvt_pk_bf16_f32 v74, v74, v74
    v_add_f32 v37, v37, v75
    v_cvt_pk_bf16_f32 v75, v75, v75
    v_add_f32 v37, v37, v76
    v_cvt_pk_bf16_f32 v76, v76, v76
    v_add_f32 v37, v37, v77
    v_cvt_pk_bf16_f32 v77, v77, v77
    v_add_f32 v37, v37, v78
    v_cvt_pk_bf16_f32 v78, v78, v78
    v_add_f32 v37, v37, v79
    v_cvt_pk_bf16_f32 v79, v79, v79
    v_add_f32 v37, v37, v80
    v_cvt_pk_bf16_f32 v80, v80, v80
    v_add_f32 v37, v37, v81
    v_cvt_pk_bf16_f32 v81, v81, v81
    v_fma_f32 v82, v82, s87, -v36
    v_fma_f32 v83, v83, s87, -v36
    v_fma_f32 v84, v84, s87, -v36
    v_fma_f32 v85, v85, s87, -v36
    v_fma_f32 v86, v86, s87, -v36
    v_fma_f32 v87, v87, s87, -v36
    v_fma_f32 v88, v88, s87, -v36
    v_fma_f32 v89, v89, s87, -v36
    v_exp_f32 v82, v82
    v_exp_f32 v83, v83
    v_exp_f32 v84, v84
    v_exp_f32 v85, v85
    v_exp_f32 v86, v86
    v_exp_f32 v87, v87
    v_exp_f32 v88, v88
    v_exp_f32 v89, v89
    v_add_f32 v37, v37, v82
    v_cvt_pk_bf16_f32 v82, v82, v82
    v_add_f32 v37, v37, v83
    v_cvt_pk_bf16_f32 v83, v83, v83
    v_add_f32 v37, v37, v84
    v_cvt_pk_bf16_f32 v84, v84, v84
    v_add_f32 v37, v37, v85
    v_cvt_pk_bf16_f32 v85, v85, v85
    v_add_f32 v37, v37, v86
    v_cvt_pk_bf16_f32 v86, v86, v86
    v_add_f32 v37, v37, v87
    v_cvt_pk_bf16_f32 v87, v87, v87
    v_add_f32 v37, v37, v88
    v_cvt_pk_bf16_f32 v88, v88, v88
    v_add_f32 v37, v37, v89
    v_cvt_pk_bf16_f32 v89, v89, v89
    v_fma_f32 v90, v90, s87, -v36
    v_fma_f32 v91, v91, s87, -v36
    v_fma_f32 v92, v92, s87, -v36
    v_fma_f32 v93, v93, s87, -v36
    v_fma_f32 v94, v94, s87, -v36
    v_fma_f32 v95, v95, s87, -v36
    v_exp_f32 v90, v90
    v_exp_f32 v91, v91
    v_exp_f32 v92, v92
    v_exp_f32 v93, v93
    v_exp_f32 v94, v94
    v_exp_f32 v95, v95
    v_add_f32 v37, v37, v90
    v_cvt_pk_bf16_f32 v90, v90, v90
    v_add_f32 v37, v37, v91
    v_cvt_pk_bf16_f32 v91, v91, v91
    v_add_f32 v37, v37, v92
    v_cvt_pk_bf16_f32 v92, v92, v92
    v_add_f32 v37, v37, v93
    v_cvt_pk_bf16_f32 v93, v93, v93
    v_add_f32 v37, v37, v94
    v_cvt_pk_bf16_f32 v94, v94, v94
    v_add_f32 v37, v37, v95
    v_cvt_pk_bf16_f32 v95, v95, v95
    s_waitcnt vmcnt(7)
    buffer_load_dwordx4 v[128:131], v3, s[32:35], s71 offen nt
    s_add_u32 s71, s71, 1024
    s_cmp_eq_u32 s71, 26624
    s_cselect_b32 s71, 0, s71
    v_mov_b32 v35, v37
    s_nop 1
    v_permlane16_swap_b32 v37, v35
    v_add_f32 v37, v37, v35
    v_mov_b32 v35, v37
    s_nop 1
    v_permlane32_swap_b32 v37, v35
    v_add_f32 v37, v37, v35
    v_mov_b32 v35, v37
    s_lshl_b32 s66, s3, 3
    v_add_u32 v32, s66, v52
    s_mov_b64 exec, 0x101
    ds_write_b64 v32, v[34:35] offset:9472
    s_mov_b64 exec, -1
    v_and_b32 v16, v58, v8
    v_and_b32 v17, v58, v9
    v_and_b32 v18, v58, v10
    v_and_b32 v19, v58, v11
    s_nop 1
    v_mfma_f32_16x16x32_bf16 v[12:15], v[16:19], v[248:251], 0
    v_and_b32 v20, v59, v8
    v_and_b32 v21, v59, v9
    v_and_b32 v22, v59, v10
    v_and_b32 v23, v59, v11
    s_nop 1
    v_mfma_f32_16x16x32_bf16 v[12:15], v[20:23], v[252:255], v[12:15]
    v_and_b32 v16, v60, v8
    v_and_b32 v17, v60, v9
    v_and_b32 v18, v60, v10
    v_and_b32 v19, v60, v11
    s_nop 1
    v_mfma_f32_16x16x32_bf16 v[12:15], v[16:19], v[96:99], v[12:15]
    v_and_b32 v20, v61, v8
    v_and_b32 v21, v61, v9
    v_and_b32 v22, v61, v10
    v_and_b32 v23, v61, v11
    s_waitcnt vmcnt(7)
    buffer_load_dwordx4 v[132:135], v3, s[32:35], s71 offen nt
    s_add_u32 s71, s71, 1024
    s_cmp_eq_u32 s71, 26624
    s_cselect_b32 s71, 0, s71
    v_mfma_f32_16x16x32_bf16 v[12:15], v[20:23], v[100:103], v[12:15]
    v_and_b32 v16, v62, v8
    v_and_b32 v17, v62, v9
    v_and_b32 v18, v62, v10
    v_and_b32 v19, v62, v11
    s_waitcnt vmcnt(7)
    buffer_load_dwordx4 v[136:139], v3, s[32:35], s71 offen nt
    s_add_u32 s71, s71, 1024
    s_cmp_eq_u32 s71, 26624
    s_cselect_b32 s71, 0, s71
    v_mfma_f32_16x16x32_bf16 v[12:15], v[16:19], v[104:107], v[12:15]
    v_and_b32 v20, v63, v8
    v_and_b32 v21, v63, v9
    v_and_b32 v22, v63, v10
    v_and_b32 v23, v63, v11
    s_waitcnt vmcnt(7)
    buffer_load_dwordx4 v[140:143], v3, s[32:35], s71 offen nt
    s_add_u32 s71, s71, 1024
    s_cmp_eq_u32 s71, 26624
    s_cselect_b32 s71, 0, s71
    v_mfma_f32_16x16x32_bf16 v[12:15], v[20:23], v[108:111], v[12:15]
    v_and_b32 v16, v64, v8
    v_and_b32 v17, v64, v9
    v_and_b32 v18, v64, v10
    v_and_b32 v19, v64, v11
    s_waitcnt vmcnt(7)
    buffer_load_dwordx4 v[144:147], v3, s[32:35], s71 offen nt
    s_add_u32 s71, s71, 1024
    s_cmp_eq_u32 s71, 26624
    s_cselect_b32 s71, 0, s71
    v_mfma_f32_16x16x32_bf16 v[12:15], v[16:19], v[112:115], v[12:15]
    v_and_b32 v20, v65, v8
    v_and_b32 v21, v65, v9
    v_and_b32 v22, v65, v10
    v_and_b32 v23, v65, v11
    s_waitcnt vmcnt(7)
    buffer_load_dwordx4 v[148:151], v3, s[32:35], s71 offen nt
    s_add_u32 s71, s71, 1024
    s_cmp_eq_u32 s71, 26624
    s_cselect_b32 s71, 0, s71
    v_mfma_f32_16x16x32_bf16 v[12:15], v[20:23], v[116:119], v[12:15]
    v_and_b32 v16, v66, v8
    v_and_b32 v17, v66, v9
    v_and_b32 v18, v66, v10
    v_and_b32 v19, v66, v11
    s_waitcnt vmcnt(7)
    s_mov_b32 s68, 26624
    buffer_load_dwordx4 v[152:155], v3, s[32:35], s68 offen nt
    v_mfma_f32_16x16x32_bf16 v[12:15], v[16:19], v[120:123], v[12:15]
    v_and_b32 v20, v67, v8
    v_and_b32 v21, v67, v9
    v_and_b32 v22, v67, v10
    v_and_b32 v23, v67, v11
    s_waitcnt vmcnt(7)
    s_mov_b32 s68, 27648
    buffer_load_dwordx4 v[156:159], v3, s[32:35], s68 offen nt
    v_mfma_f32_16x16x32_bf16 v[12:15], v[20:23], v[124:127], v[12:15]
    v_and_b32 v16, v68, v8
    v_and_b32 v17, v68, v9
    v_and_b32 v18, v68, v10
    v_and_b32 v19, v68, v11
    s_waitcnt vmcnt(7)
    s_mov_b32 s68, 28672
    buffer_load_dwordx4 v[160:163], v3, s[32:35], s68 offen nt
    v_mfma_f32_16x16x32_bf16 v[12:15], v[16:19], v[128:131], v[12:15]
    v_and_b32 v20, v69, v8
    v_and_b32 v21, v69, v9
    v_and_b32 v22, v69, v10
    v_and_b32 v23, v69, v11
    s_waitcnt vmcnt(7)
    s_mov_b32 s68, 29696
    buffer_load_dwordx4 v[164:167], v3, s[32:35], s68 offen nt
    v_mfma_f32_16x16x32_bf16 v[12:15], v[20:23], v[132:135], v[12:15]
    v_and_b32 v16, v70, v8
    v_and_b32 v17, v70, v9
    v_and_b32 v18, v70, v10
    v_and_b32 v19, v70, v11
    s_waitcnt vmcnt(7)
    s_mov_b32 s68, 30720
    buffer_load_dwordx4 v[168:171], v3, s[32:35], s68 offen nt
    v_mfma_f32_16x16x32_bf16 v[12:15], v[16:19], v[136:139], v[12:15]
    v_and_b32 v20, v71, v8
    v_and_b32 v21, v71, v9
    v_and_b32 v22, v71, v10
    v_and_b32 v23, v71, v11
    s_waitcnt vmcnt(7)
    s_mov_b32 s68, 31744
    buffer_load_dwordx4 v[172:175], v3, s[32:35], s68 offen nt
    v_mfma_f32_16x16x32_bf16 v[12:15], v[20:23], v[140:143], v[12:15]
    v_and_b32 v16, v72, v8
    v_and_b32 v17, v72, v9
    v_and_b32 v18, v72, v10
    v_and_b32 v19, v72, v11
    s_waitcnt vmcnt(7)
    s_mov_b32 s68, 32768
    buffer_load_dwordx4 v[176:179], v3, s[32:35], s68 offen nt
    v_mfma_f32_16x16x32_bf16 v[12:15], v[16:19], v[144:147], v[12:15]
    v_and_b32 v20, v73, v8
    v_and_b32 v21, v73, v9
    v_and_b32 v22, v73, v10
    v_and_b32 v23, v73, v11
    s_waitcnt vmcnt(7)
    s_mov_b32 s68, 33792
    buffer_load_dwordx4 v[180:183], v3, s[32:35], s68 offen nt
    v_mfma_f32_16x16x32_bf16 v[12:15], v[20:23], v[148:151], v[12:15]
    v_and_b32 v16, v74, v8
    v_and_b32 v17, v74, v9
    v_and_b32 v18, v74, v10
    v_and_b32 v19, v74, v11
    s_waitcnt vmcnt(7)
    s_mov_b32 s68, 34816
    buffer_load_dwordx4 v[184:187], v3, s[32:35], s68 offen nt
    v_mfma_f32_16x16x32_bf16 v[12:15], v[16:19], v[152:155], v[12:15]
    v_and_b32 v20, v75, v8
    v_and_b32 v21, v75, v9
    v_and_b32 v22, v75, v10
    v_and_b32 v23, v75, v11
    s_waitcnt vmcnt(7)
    s_mov_b32 s68, 35840
    buffer_load_dwordx4 v[188:191], v3, s[32:35], s68 offen nt
    v_mfma_f32_16x16x32_bf16 v[12:15], v[20:23], v[156:159], v[12:15]
    v_and_b32 v16, v76, v8
    v_and_b32 v17, v76, v9
    v_and_b32 v18, v76, v10
    v_and_b32 v19, v76, v11
    s_waitcnt vmcnt(7)
    s_mov_b32 s68, 36864
    buffer_load_dwordx4 v[192:195], v3, s[32:35], s68 offen nt
    v_mfma_f32_16x16x32_bf16 v[12:15], v[16:19], v[160:163], v[12:15]
    v_and_b32 v20, v77, v8
    v_and_b32 v21, v77, v9
    v_and_b32 v22, v77, v10
    v_and_b32 v23, v77, v11
    s_waitcnt vmcnt(7)
    s_mov_b32 s68, 37888
    buffer_load_dwordx4 v[196:199], v3, s[32:35], s68 offen nt
    v_mfma_f32_16x16x32_bf16 v[12:15], v[20:23], v[164:167], v[12:15]
    v_and_b32 v16, v78, v8
    v_and_b32 v17, v78, v9
    v_and_b32 v18, v78, v10
    v_and_b32 v19, v78, v11
    s_waitcnt vmcnt(7)
    buffer_load_dwordx4 v[200:203], v3, s[32:35], s71 offen nt
    s_add_u32 s71, s71, 1024
    s_cmp_eq_u32 s71, 26624
    s_cselect_b32 s71, 0, s71
    v_mfma_f32_16x16x32_bf16 v[12:15], v[16:19], v[168:171], v[12:15]
    v_and_b32 v20, v79, v8
    v_and_b32 v21, v79, v9
    v_and_b32 v22, v79, v10
    v_and_b32 v23, v79, v11
    s_waitcnt vmcnt(7)
    buffer_load_dwordx4 v[204:207], v3, s[32:35], s71 offen nt
    s_add_u32 s71, s71, 1024
    s_cmp_eq_u32 s71, 26624
    s_cselect_b32 s71, 0, s71
    v_mfma_f32_16x16x32_bf16 v[12:15], v[20:23], v[172:175], v[12:15]
    v_and_b32 v16, v80, v8
    v_and_b32 v17, v80, v9
    v_and_b32 v18, v80, v10
    v_and_b32 v19, v80, v11
    s_waitcnt vmcnt(7)
    buffer_load_dwordx4 v[208:211], v3, s[32:35], s71 offen nt
    s_add_u32 s71, s71, 1024
    s_cmp_eq_u32 s71, 26624
    s_cselect_b32 s71, 0, s71
    v_mfma_f32_16x16x32_bf16 v[12:15], v[16:19], v[176:179], v[12:15]
    v_and_b32 v20, v81, v8
    v_and_b32 v21, v81, v9
    v_and_b32 v22, v81, v10
    v_and_b32 v23, v81, v11
    s_waitcnt vmcnt(7)
    buffer_load_dwordx4 v[212:215], v3, s[32:35], s71 offen nt
    s_add_u32 s71, s71, 1024
    s_cmp_eq_u32 s71, 26624
    s_cselect_b32 s71, 0, s71
    v_mfma_f32_16x16x32_bf16 v[12:15], v[20:23], v[180:183], v[12:15]
    v_and_b32 v16, v82, v8
    v_and_b32 v17, v82, v9
    v_and_b32 v18, v82, v10
    v_and_b32 v19, v82, v11
    s_waitcnt vmcnt(7)
    buffer_load_dwordx4 v[216:219], v3, s[32:35], s71 offen nt
    s_add_u32 s71, s71, 1024
    s_cmp_eq_u32 s71, 26624
    s_cselect_b32 s71, 0, s71
    v_mfma_f32_16x16x32_bf16 v[12:15], v[16:19], v[184:187], v[12:15]
    v_and_b32 v20, v83, v8
    v_and_b32 v21, v83, v9
    v_and_b32 v22, v83, v10
    v_and_b32 v23, v83, v11
    s_waitcnt vmcnt(7)
    buffer_load_dwordx4 v[220:223], v3, s[32:35], s71 offen nt
    s_add_u32 s71, s71, 1024
    s_cmp_eq_u32 s71, 26624
    s_cselect_b32 s71, 0, s71
    v_mfma_f32_16x16x32_bf16 v[12:15], v[20:23], v[188:191], v[12:15]
    v_and_b32 v16, v84, v8
    v_and_b32 v17, v84, v9
    v_and_b32 v18, v84, v10
    v_and_b32 v19, v84, v11
    s_waitcnt vmcnt(7)
    buffer_load_dwordx4 v[224:227], v3, s[32:35], s71 offen nt
    s_add_u32 s71, s71, 1024
    s_cmp_eq_u32 s71, 26624
    s_cselect_b32 s71, 0, s71
    v_mfma_f32_16x16x32_bf16 v[12:15], v[16:19], v[192:195], v[12:15]
    v_and_b32 v20, v85, v8
    v_and_b32 v21, v85, v9
    v_and_b32 v22, v85, v10
    v_and_b32 v23, v85, v11
    s_waitcnt vmcnt(7)
    buffer_load_dwordx4 v[228:231], v3, s[32:35], s71 offen nt
    s_add_u32 s71, s71, 1024
    s_cmp_eq_u32 s71, 26624
    s_cselect_b32 s71, 0, s71
    v_mfma_f32_16x16x32_bf16 v[12:15], v[20:23], v[196:199], v[12:15]
    v_and_b32 v16, v86, v8
    v_and_b32 v17, v86, v9
    v_and_b32 v18, v86, v10
    v_and_b32 v19, v86, v11
    s_waitcnt vmcnt(7)
    buffer_load_dwordx4 v[232:235], v3, s[32:35], s71 offen nt
    s_add_u32 s71, s71, 1024
    s_cmp_eq_u32 s71, 26624
    s_cselect_b32 s71, 0, s71
    v_mfma_f32_16x16x32_bf16 v[12:15], v[16:19], v[200:203], v[12:15]
    v_and_b32 v20, v87, v8
    v_and_b32 v21, v87, v9
    v_and_b32 v22, v87, v10
    v_and_b32 v23, v87, v11
    s_waitcnt vmcnt(7)
    buffer_load_dwordx4 v[236:239], v3, s[32:35], s71 offen nt
    s_add_u32 s71, s71, 1024
    s_cmp_eq_u32 s71, 26624
    s_cselect_b32 s71, 0, s71
    v_mfma_f32_16x16x32_bf16 v[12:15], v[20:23], v[204:207], v[12:15]
    v_and_b32 v16, v88, v8
    v_and_b32 v17, v88, v9
    v_and_b32 v18, v88, v10
    v_and_b32 v19, v88, v11
    s_waitcnt lgkmcnt(0)
    s_barrier
    v_lshrrev_b32 v50, 5, v1
    v_lshlrev_b32 v51, 6, v50
    ds_read_b128 v[240:243], v51 offset:9472
    ds_read_b128 v[244:247], v51 offset:9488
    ds_read_b128 v[248:251], v51 offset:9504
    ds_read_b128 v[252:255], v51 offset:9520
    s_lshl_b32 s66, s3, 3
    v_add_u32 v51, s66, v51
    ds_read_b32 v44, v51 offset:9472
    v_and_b32 v48, 15, v1
    v_lshlrev_b32 v48, 5, v48
    v_bfe_u32 v49, v1, 4, 1
    v_lshl_add_u32 v48, v49, 4, v48
    v_lshl_add_u32 v48, v50, 9, v48
    v_lshlrev_b32 v49, 4, v50
    s_lshl_b32 s66, s3, 10
    v_add_u32 v48, s66, v48
    s_lshl_b32 s83, s26, 11
    s_add_u32 s83, s83, 5242880
    s_waitcnt lgkmcnt(0)
    v_max3_f32 v46, v240, v242, v244
    v_max3_f32 v46, v46, v246, v248
    v_max3_f32 v46, v46, v250, v252
    v_max_f32 v46, v46, v254
    v_mov_b32 v47, 0
    v_sub_f32 v240, v240, v46
    v_mul_f32 v240, s87, v240
    v_exp_f32 v240, v240
    v_sub_f32 v242, v242, v46
    v_mul_f32 v242, s87, v242
    v_exp_f32 v242, v242
    v_sub_f32 v244, v244, v46
    v_mul_f32 v244, s87, v244
    v_exp_f32 v244, v244
    v_sub_f32 v246, v246, v46
    v_mul_f32 v246, s87, v246
    v_exp_f32 v246, v246
    v_sub_f32 v248, v248, v46
    v_mul_f32 v248, s87, v248
    v_exp_f32 v248, v248
    v_sub_f32 v250, v250, v46
    v_mul_f32 v250, s87, v250
    v_exp_f32 v250, v250
    v_sub_f32 v252, v252, v46
    v_mul_f32 v252, s87, v252
    v_exp_f32 v252, v252
    v_sub_f32 v254, v254, v46
    v_mul_f32 v254, s87, v254
    v_exp_f32 v254, v254
    v_fmac_f32 v47, v240, v241
    v_fmac_f32 v47, v242, v243
    v_fmac_f32 v47, v244, v245
    v_fmac_f32 v47, v246, v247
    v_fmac_f32 v47, v248, v249
    v_fmac_f32 v47, v250, v251
    v_fmac_f32 v47, v252, v253
    v_fmac_f32 v47, v254, v255
    v_sub_f32 v44, v44, v46
    v_mul_f32 v44, s87, v44
    v_exp_f32 v44, v44
    v_rcp_f32 v50, v47
    s_nop 0
    v_mul_f32 v44, v44, v50
    v_mov_b32 v32, v46
    v_mov_b32 v33, s97
    v_mov_b32 v34, v47
    v_mov_b32 v35, s98
    s_cmp_eq_u32 s3, 7
    s_cselect_b32 s66, s83, 0x7F000000
    s_mov_b32 exec_lo, 1
    s_mov_b32 exec_hi, 1
    buffer_store_dwordx4 v[32:35], v49, s[36:39], s66 offen offset:1024 sc1
    s_mov_b64 exec, -1
    s_waitcnt vmcnt(8)
    v_mfma_f32_16x16x32_bf16 v[12:15], v[16:19], v[208:211], v[12:15]
    v_and_b32 v20, v89, v8
    v_and_b32 v21, v89, v9
    v_and_b32 v22, v89, v10
    v_and_b32 v23, v89, v11
    s_waitcnt vmcnt(7)
    s_nop 0
    v_mfma_f32_16x16x32_bf16 v[12:15], v[20:23], v[212:215], v[12:15]
    v_and_b32 v16, v90, v8
    v_and_b32 v17, v90, v9
    v_and_b32 v18, v90, v10
    v_and_b32 v19, v90, v11
    s_waitcnt vmcnt(6)
    s_nop 0
    v_mfma_f32_16x16x32_bf16 v[12:15], v[16:19], v[216:219], v[12:15]
    v_and_b32 v20, v91, v8
    v_and_b32 v21, v91, v9
    v_and_b32 v22, v91, v10
    v_and_b32 v23, v91, v11
    s_waitcnt vmcnt(5)
    s_nop 0
    v_mfma_f32_16x16x32_bf16 v[12:15], v[20:23], v[220:223], v[12:15]
    v_and_b32 v16, v92, v8
    v_and_b32 v17, v92, v9
    v_and_b32 v18, v92, v10
    v_and_b32 v19, v92, v11
    s_waitcnt vmcnt(4)
    s_nop 0
    v_mfma_f32_16x16x32_bf16 v[12:15], v[16:19], v[224:227], v[12:15]
    v_and_b32 v20, v93, v8
    v_and_b32 v21, v93, v9
    v_and_b32 v22, v93, v10
    v_and_b32 v23, v93, v11
    s_waitcnt vmcnt(3)
    s_nop 0
    v_mfma_f32_16x16x32_bf16 v[12:15], v[20:23], v[228:231], v[12:15]
    v_and_b32 v16, v94, v8
    v_and_b32 v17, v94, v9
    v_and_b32 v18, v94, v10
    v_and_b32 v19, v94, v11
    s_waitcnt vmcnt(2)
    s_nop 0
    v_mfma_f32_16x16x32_bf16 v[12:15], v[16:19], v[232:235], v[12:15]
    v_and_b32 v20, v95, v8
    v_and_b32 v21, v95, v9
    v_and_b32 v22, v95, v10
    v_and_b32 v23, v95, v11
    s_waitcnt vmcnt(1)
    s_nop 0
    v_mfma_f32_16x16x32_bf16 v[12:15], v[20:23], v[236:239], v[12:15]
    s_nop 7
    v_mul_f32 v12, v12, v44
    v_mul_f32 v13, v13, v44
    v_mul_f32 v14, v14, v44
    v_mul_f32 v15, v15, v44
    ds_write_b128 v48, v[12:15] offset:0
    s_waitcnt lgkmcnt(0)
    s_barrier
    s_cmp_lg_u32 s3, 7
    s_cbranch_scc1 L_not7
    ds_read_b128 v[128:131], v3 offset:0
    ds_read_b128 v[132:135], v3 offset:1024
    ds_read_b128 v[136:139], v3 offset:2048
    ds_read_b128 v[140:143], v3 offset:3072
    ds_read_b128 v[144:147], v3 offset:4096
    ds_read_b128 v[148:151], v3 offset:5120
    ds_read_b128 v[152:155], v3 offset:6144
    ds_read_b128 v[156:159], v3 offset:7168
    s_waitcnt lgkmcnt(6)
    v_pk_add_f32 v[128:129], v[128:129], v[132:133]
    v_pk_add_f32 v[130:131], v[130:131], v[134:135]
    s_waitcnt lgkmcnt(5)
    v_pk_add_f32 v[128:129], v[128:129], v[136:137]
    v_pk_add_f32 v[130:131], v[130:131], v[138:139]
    s_waitcnt lgkmcnt(4)
    v_pk_add_f32 v[128:129], v[128:129], v[140:141]
    v_pk_add_f32 v[130:131], v[130:131], v[142:143]
    s_waitcnt lgkmcnt(3)
    v_pk_add_f32 v[128:129], v[128:129], v[144:145]
    v_pk_add_f32 v[130:131], v[130:131], v[146:147]
    s_waitcnt lgkmcnt(2)
    v_pk_add_f32 v[128:129], v[128:129], v[148:149]
    v_pk_add_f32 v[130:131], v[130:131], v[150:151]
    s_waitcnt lgkmcnt(1)
    v_pk_add_f32 v[128:129], v[128:129], v[152:153]
    v_pk_add_f32 v[130:131], v[130:131], v[154:155]
    s_waitcnt lgkmcnt(0)
    v_pk_add_f32 v[128:129], v[128:129], v[156:157]
    v_pk_add_f32 v[130:131], v[130:131], v[158:159]
    v_bfi_b32 v128, s69, v128, v54
    v_bfi_b32 v129, s69, v129, v55
    v_bfi_b32 v130, s69, v130, v54
    v_bfi_b32 v131, s69, v131, v55
    buffer_store_dwordx4 v[128:131], v3, s[36:39], s83 offen sc1
L_not7:
    s_cmp_ge_u32 s67, 48
    s_cbranch_scc1 L_nwo
    s_lshl_b32 s66, s74, 15
    s_lshl_b32 s68, s3, 11
    s_add_u32 s68, s68, s66
    s_add_u32 s68, s68, 5242880
    s_add_u32 s85, s68, 16384
    v_lshrrev_b32 v111, 5, v1
    v_lshlrev_b32 v111, 4, v111
    s_mul_i32 s66, s3, 544
    s_add_u32 s66, s66, 110080
    v_add_u32 v112, s66, v52
    s_mov_b32 s80, 0
    buffer_load_dwordx4 v[72:75], v111, s[36:39], s68 offen offset:1024 sc1
    buffer_load_dwordx4 v[76:79], v111, s[36:39], s85 offen offset:1024 sc1
    s_cmp_ge_u32 s3, 6
    s_cbranch_scc1 L_wof_done
    v_lshlrev_b32 v113, 3, v41
    v_add_u32 v113, v113, v42
    v_lshlrev_b32 v113, 7, v113
    v_lshl_add_u32 v113, v43, 3, v113
    v_and_b32 v118, 1, v41
    v_lshlrev_b32 v118, 1, v118
    v_lshrrev_b32 v119, 1, v42
    v_or_b32 v118, v118, v119
    s_lshr_b32 s66, s3, 1
    s_lshl_b32 s66, s66, 15
    s_add_u32 s66, s66, 11776
    v_add_u32 v113, s66, v113
    s_and_b32 s66, s3, 1
    s_lshl_b32 s66, s66, 1
    v_xor_b32 v119, s66, v118
    v_lshl_add_u32 v114, v119, 5, v113
    v_xor_b32 v115, 32, v114
    s_mul_i32 s84, s74, 18432
    v_and_b32 v120, 7, v1
    v_mul_u32_u24 v120, 544, v120
    v_lshl_add_u32 v120, v41, 4, v120
    v_add_u32 v120, 110080, v120
    s_mul_i32 s66, s75, 6
    s_add_u32 s66, s66, s3
    s_lshl_b32 s66, s66, 7
    s_add_u32 s84, s84, s66
    s_add_u32 s84, s84, 327680
    s_mul_i32 s66, s3, 1152
    s_add_u32 s66, s66, 114688
    v_and_b32 v121, 7, v1
    v_lshlrev_b32 v123, 4, v121
    v_mul_u32_u24 v121, 144, v121
    v_bfe_u32 v122, v1, 3, 1
    v_lshl_add_u32 v121, v122, 6, v121
    v_lshl_add_u32 v121, v41, 4, v121
    v_add_u32 v121, s66, v121
    v_lshrrev_b32 v119, 3, v1
    v_mul_u32_u24 v122, 144, v119
    v_add3_u32 v122, v122, v123, s66
    v_mul_u32_u24 v119, 2304, v119
    v_add_u32 v123, v123, v119
    ds_read_b64_tr_b16 v[128:129], v114 offset:0
    ds_read_b64_tr_b16 v[130:131], v114 offset:512
    ds_read_b64_tr_b16 v[132:133], v114 offset:4096
    ds_read_b64_tr_b16 v[134:135], v114 offset:4608
    ds_read_b64_tr_b16 v[136:137], v114 offset:8192
    ds_read_b64_tr_b16 v[138:139], v114 offset:8704
    ds_read_b64_tr_b16 v[140:141], v114 offset:12288
    ds_read_b64_tr_b16 v[142:143], v114 offset:12800
    s_waitcnt lgkmcnt(0)
    ds_read_b64_tr_b16 v[144:145], v114 offset:16384
    ds_read_b64_tr_b16 v[146:147], v114 offset:16896
    ds_read_b64_tr_b16 v[148:149], v114 offset:20480
    ds_read_b64_tr_b16 v[150:151], v114 offset:20992
    ds_read_b64_tr_b16 v[152:153], v114 offset:24576
    ds_read_b64_tr_b16 v[154:155], v114 offset:25088
    ds_read_b64_tr_b16 v[156:157], v114 offset:28672
    ds_read_b64_tr_b16 v[158:159], v114 offset:29184
    s_waitcnt lgkmcnt(0)
    ds_read_b64_tr_b16 v[160:161], v115 offset:0
    ds_read_b64_tr_b16 v[162:163], v115 offset:512
    ds_read_b64_tr_b16 v[164:165], v115 offset:4096
    ds_read_b64_tr_b16 v[166:167], v115 offset:4608
    ds_read_b64_tr_b16 v[168:169], v115 offset:8192
    ds_read_b64_tr_b16 v[170:171], v115 offset:8704
    ds_read_b64_tr_b16 v[172:173], v115 offset:12288
    ds_read_b64_tr_b16 v[174:175], v115 offset:12800
    s_waitcnt lgkmcnt(0)
    ds_read_b64_tr_b16 v[176:177], v115 offset:16384
    ds_read_b64_tr_b16 v[178:179], v115 offset:16896
    ds_read_b64_tr_b16 v[180:181], v115 offset:20480
    ds_read_b64_tr_b16 v[182:183], v115 offset:20992
    ds_read_b64_tr_b16 v[184:185], v115 offset:24576
    ds_read_b64_tr_b16 v[186:187], v115 offset:25088
    ds_read_b64_tr_b16 v[188:189], v115 offset:28672
    ds_read_b64_tr_b16 v[190:191], v115 offset:29184
    s_waitcnt lgkmcnt(0)
L_wof_done:
    s_branch L_pfirst_3
L_poll_1:
    s_add_u32 s80, s80, 1
    s_cmp_gt_u32 s80, 1000000
    s_cbranch_scc1 L_pdone_2
    s_sleep 1
    buffer_load_dwordx4 v[72:75], v111, s[36:39], s68 offen offset:1024 sc1
    buffer_load_dwordx4 v[76:79], v111, s[36:39], s85 offen offset:1024 sc1
L_pfirst_3:
    s_waitcnt vmcnt(0)
    v_xor_b32 v73, s97, v73
    v_xor_b32 v75, s98, v75
    v_xor_b32 v77, s97, v77
    v_xor_b32 v79, s98, v79
    v_or_b32 v98, v73, v75
    v_or3_b32 v98, v98, v77, v79
    v_and_b32 v98, -1, v98
    v_cmp_ne_u32 vcc, 0, v98
    s_nop 0
    s_mov_b64 exec, vcc
    s_cbranch_vccnz L_poll_1
L_pdone_2:
    s_mov_b64 exec, -1
    s_mov_b32 s80, 0
    buffer_load_dwordx4 v[64:67], v3, s[36:39], s68 offen sc1
    buffer_load_dwordx4 v[68:71], v3, s[36:39], s85 offen sc1
    v_max_f32 v100, v72, v76
    v_sub_f32 v72, v72, v100
    v_sub_f32 v76, v76, v100
    v_mul_f32 v72, s87, v72
    v_mul_f32 v76, s87, v76
    v_exp_f32 v72, v72
    v_exp_f32 v76, v76
    v_mul_f32 v72, v72, v74
    v_mul_f32 v74, v76, v78
    v_add_f32 v100, v72, v74
    v_rcp_f32 v100, v100
    s_nop 0
    v_mul_f32 v72, v72, v100
    v_mul_f32 v74, v74, v100
    v_mov_b32 v73, v72
    v_mov_b32 v75, v74
    s_branch L_pfirst_6
L_poll_4:
    s_add_u32 s80, s80, 1
    s_cmp_gt_u32 s80, 1000000
    s_cbranch_scc1 L_pdone_5
    s_sleep 1
    buffer_load_dwordx4 v[64:67], v3, s[36:39], s68 offen sc1
    buffer_load_dwordx4 v[68:71], v3, s[36:39], s85 offen sc1
L_pfirst_6:
    s_waitcnt vmcnt(0)
    v_xor_b32 v64, s92, v64
    v_xor_b32 v65, s93, v65
    v_xor_b32 v66, s92, v66
    v_xor_b32 v67, s93, v67
    v_xor_b32 v68, s92, v68
    v_xor_b32 v69, s93, v69
    v_xor_b32 v70, s92, v70
    v_xor_b32 v71, s93, v71
    v_or_b32 v98, v64, v65
    v_or3_b32 v98, v98, v66, v67
    v_or3_b32 v98, v98, v68, v69
    v_or3_b32 v98, v98, v70, v71
    v_and_b32 v98, 0x3ff, v98
    v_cmp_ne_u32 vcc, 0, v98
    s_nop 0
    s_mov_b64 exec, vcc
    s_cbranch_vccnz L_poll_4
L_pdone_5:
    s_mov_b64 exec, -1
    v_pk_mul_f32 v[64:65], v[64:65], v[72:73]
    v_pk_mul_f32 v[66:67], v[66:67], v[72:73]
    v_pk_fma_f32 v[64:65], v[68:69], v[74:75], v[64:65]
    v_pk_fma_f32 v[66:67], v[70:71], v[74:75], v[66:67]
    v_cvt_pk_bf16_f32 v64, v64, v65
    v_cvt_pk_bf16_f32 v65, v66, v67
    ds_write_b64 v112, v[64:65]
    s_waitcnt lgkmcnt(0)
    s_barrier
    s_cmp_ge_u32 s3, 6
    s_cbranch_scc1 L_nwo
    ds_read_b128 v[224:227], v120 offset:0
    ds_read_b128 v[228:231], v120 offset:64
    ds_read_b128 v[232:235], v120 offset:128
    ds_read_b128 v[236:239], v120 offset:192
    ds_read_b128 v[240:243], v120 offset:256
    ds_read_b128 v[244:247], v120 offset:320
    ds_read_b128 v[248:251], v120 offset:384
    ds_read_b128 v[252:255], v120 offset:448
    s_waitcnt lgkmcnt(7)
    v_mfma_f32_16x16x32_bf16 v[192:195], v[128:131], v[224:227], 0
    v_mfma_f32_16x16x32_bf16 v[196:199], v[160:163], v[224:227], 0
    s_waitcnt lgkmcnt(6)
    v_mfma_f32_16x16x32_bf16 v[192:195], v[132:135], v[228:231], v[192:195]
    v_mfma_f32_16x16x32_bf16 v[196:199], v[164:167], v[228:231], v[196:199]
    s_waitcnt lgkmcnt(5)
    v_mfma_f32_16x16x32_bf16 v[192:195], v[136:139], v[232:235], v[192:195]
    v_mfma_f32_16x16x32_bf16 v[196:199], v[168:171], v[232:235], v[196:199]
    s_waitcnt lgkmcnt(4)
    v_mfma_f32_16x16x32_bf16 v[192:195], v[140:143], v[236:239], v[192:195]
    v_mfma_f32_16x16x32_bf16 v[196:199], v[172:175], v[236:239], v[196:199]
    s_waitcnt lgkmcnt(3)
    v_mfma_f32_16x16x32_bf16 v[192:195], v[144:147], v[240:243], v[192:195]
    v_mfma_f32_16x16x32_bf16 v[196:199], v[176:179], v[240:243], v[196:199]
    s_waitcnt lgkmcnt(2)
    v_mfma_f32_16x16x32_bf16 v[192:195], v[148:151], v[244:247], v[192:195]
    v_mfma_f32_16x16x32_bf16 v[196:199], v[180:183], v[244:247], v[196:199]
    s_waitcnt lgkmcnt(1)
    v_mfma_f32_16x16x32_bf16 v[192:195], v[152:155], v[248:251], v[192:195]
    v_mfma_f32_16x16x32_bf16 v[196:199], v[184:187], v[248:251], v[196:199]
    s_waitcnt lgkmcnt(0)
    v_mfma_f32_16x16x32_bf16 v[192:195], v[156:159], v[252:255], v[192:195]
    v_mfma_f32_16x16x32_bf16 v[196:199], v[188:191], v[252:255], v[196:199]
    s_nop 7
    v_cndmask_b32 v208, v192, v196, s[88:89]
    v_cndmask_b32 v209, v193, v197, s[88:89]
    v_cndmask_b32 v210, v194, v198, s[88:89]
    v_cndmask_b32 v211, v195, v199, s[88:89]
    v_bfi_b32 v208, s69, v208, v54
    v_bfi_b32 v209, s69, v209, v55
    v_bfi_b32 v210, s69, v210, v54
    v_bfi_b32 v211, s69, v211, v55
    ds_write_b128 v121, v[208:211]
    ds_read_b128 v[212:215], v122
    s_waitcnt lgkmcnt(0)
    buffer_store_dwordx4 v[212:215], v123, s[36:39], s84 offen sc1
L_nwo:
    s_sub_u32 s66, s63, 48
    s_cmp_lt_u32 s63, 64
    s_cselect_b32 s66, s63, s66
    s_sub_u32 s68, s63, 64
    s_cmp_lt_u32 s68, 48
    s_cselect_b32 s66, 999, s66
    s_cmp_ge_u32 s63, 184
    s_cselect_b32 s66, 999, s66
    s_cmp_eq_u32 s3, 4
    s_cselect_b32 s66, s66, 999
    s_add_u32 s68, s63, 136
    s_cmp_eq_u32 s3, 5
    s_cselect_b32 s66, s68, s66
    s_cmp_ge_u32 s66, 144
    s_cbranch_scc1 L_nb1
    s_mul_i32 s74, s66, 3641
    s_lshr_b32 s74, s74, 16
    s_mul_i32 s75, s74, 18
    s_sub_u32 s75, s66, s75
    v_and_b32 v120, 7, v1
    v_lshrrev_b32 v121, 3, v1
    v_mul_u32_u24 v111, 18432, v121
    v_lshl_add_u32 v111, v120, 4, v111
    s_mul_i32 s66, s74, 2304
    s_lshl_b32 s68, s75, 7
    s_add_u32 s66, s66, s68
    s_add_u32 s84, s66, 6291456
    s_lshr_b32 s83, s66, 1
    s_add_u32 s66, s66, 327680
    s_add_u32 s67, s66, 147456
    v_lshlrev_b32 v112, 3, v120
    buffer_load_dwordx2 v[100:101], v112, s[40:43], s83 offen
    v_mov_b32 v58, s90
    v_mov_b32 v59, s91
    s_waitcnt vmcnt(0)
    v_lshlrev_b32 v96, 16, v100
    v_and_b32 v97, 0xffff0000, v100
    v_lshlrev_b32 v98, 16, v101
    v_and_b32 v99, 0xffff0000, v101
    s_mov_b32 s80, 0
    buffer_load_dwordx4 v[128:131], v111, s[36:39], s66 offen sc1
    buffer_load_dwordx4 v[132:135], v111, s[36:39], s67 offen sc1
    s_branch L_pfirst_9
L_poll_7:
    s_add_u32 s80, s80, 1
    s_cmp_gt_u32 s80, 1000000
    s_cbranch_scc1 L_pdone_8
    s_sleep 1
    buffer_load_dwordx4 v[128:131], v111, s[36:39], s66 offen sc1
    buffer_load_dwordx4 v[132:135], v111, s[36:39], s67 offen sc1
L_pfirst_9:
    s_waitcnt vmcnt(0)
    v_xor_b32 v128, s92, v128
    v_xor_b32 v129, s93, v129
    v_xor_b32 v130, s92, v130
    v_xor_b32 v131, s93, v131
    v_xor_b32 v132, s92, v132
    v_xor_b32 v133, s93, v133
    v_xor_b32 v134, s92, v134
    v_xor_b32 v135, s93, v135
    v_or_b32 v102, v128, v129
    v_or3_b32 v102, v102, v130, v131
    v_or3_b32 v102, v102, v132, v133
    v_or3_b32 v102, v102, v134, v135
    v_and_b32 v102, 0x3ff, v102
    v_cmp_ne_u32 vcc, 0, v102
    s_nop 0
    s_mov_b64 exec, vcc
    s_cbranch_vccnz L_poll_7
L_pdone_8:
    s_mov_b64 exec, -1
    v_pk_add_f32 v[128:129], v[128:129], v[132:133]
    v_pk_add_f32 v[130:131], v[130:131], v[134:135]
    s_nop 0
    v_add_f32_dpp v128, v128, v128 row_ror:8 row_mask:0xf bank_mask:0xf
    v_add_f32_dpp v129, v129, v129 row_ror:8 row_mask:0xf bank_mask:0xf
    v_add_f32_dpp v130, v130, v130 row_ror:8 row_mask:0xf bank_mask:0xf
    v_add_f32_dpp v131, v131, v131 row_ror:8 row_mask:0xf bank_mask:0xf
    v_mov_b32 v132, v128
    v_mov_b32 v133, v129
    v_mov_b32 v134, v130
    v_mov_b32 v135, v131
    v_permlane16_swap_b32 v128, v132
    v_permlane16_swap_b32 v129, v133
    v_permlane16_swap_b32 v130, v134
    v_permlane16_swap_b32 v131, v135
    v_pk_add_f32 v[128:129], v[128:129], v[132:133]
    v_pk_add_f32 v[130:131], v[130:131], v[134:135]
    v_mov_b32 v132, v128
    v_mov_b32 v133, v129
    v_mov_b32 v134, v130
    v_mov_b32 v135, v131
    v_permlane32_swap_b32 v128, v132
    v_permlane32_swap_b32 v129, v133
    v_permlane32_swap_b32 v130, v134
    v_permlane32_swap_b32 v131, v135
    v_pk_add_f32 v[128:129], v[128:129], v[132:133]
    v_pk_add_f32 v[130:131], v[130:131], v[134:135]
    v_cvt_pk_bf16_f32 v128, v128, v129
    v_cvt_pk_bf16_f32 v130, v130, v131
    v_and_b32 v129, 0xffff0000, v128
    v_lshlrev_b32 v128, 16, v128
    v_and_b32 v131, 0xffff0000, v130
    v_lshlrev_b32 v130, 16, v130
    v_pk_add_f32 v[128:129], v[128:129], v[96:97]
    v_pk_add_f32 v[130:131], v[130:131], v[98:99]
    v_cvt_pk_bf16_f32 v129, v128, v129
    v_cvt_pk_bf16_f32 v131, v130, v131
    v_lshl_or_b32 v128, v129, 16, v58
    v_and_or_b32 v129, v129, s99, v59
    v_lshl_or_b32 v130, v131, 16, v58
    v_and_or_b32 v131, v131, s99, v59
    s_mov_b64 exec, 0xff
    buffer_store_dwordx4 v[128:131], v3, s[36:39], s84 offen sc1
    s_mov_b64 exec, -1
L_nb1:
    s_cmp_lt_u32 s63, 184
    s_cbranch_scc1 L_nmlp
    s_lshl_b32 s66, s3, 10
    s_add_u32 s66, s66, 11776
    s_mul_i32 s68, s3, 73728
    s_add_u32 s68, s68, 0
    s_cmp_ge_u32 s63, 184
    s_cselect_b32 s66, s66, 10752
    s_mov_b32 m0, s66
    s_nop 0
    buffer_load_dwordx4 v40, s[52:55], s68 offen nt lds
    s_lshl_b32 s66, s3, 10
    s_add_u32 s66, s66, 19968
    s_mul_i32 s68, s3, 73728
    s_add_u32 s68, s68, 589824
    s_cmp_ge_u32 s63, 184
    s_cselect_b32 s66, s66, 10752
    s_mov_b32 m0, s66
    s_nop 0
    buffer_load_dwordx4 v40, s[52:55], s68 offen nt lds
    s_lshl_b32 s66, s3, 10
    s_add_u32 s66, s66, 28160
    s_mul_i32 s68, s3, 73728
    s_add_u32 s68, s68, 1179648
    s_cmp_ge_u32 s63, 184
    s_cselect_b32 s66, s66, 10752
    s_mov_b32 m0, s66
    s_nop 0
    buffer_load_dwordx4 v40, s[52:55], s68 offen nt lds
    s_lshl_b32 s66, s3, 10
    s_add_u32 s66, s66, 36352
    s_mul_i32 s68, s3, 73728
    s_add_u32 s68, s68, 1769472
    s_cmp_ge_u32 s63, 184
    s_cselect_b32 s66, s66, 10752
    s_mov_b32 m0, s66
    s_nop 0
    buffer_load_dwordx4 v40, s[52:55], s68 offen nt lds
    s_lshl_b32 s66, s3, 10
    s_add_u32 s66, s66, 44544
    s_mul_i32 s68, s3, 73728
    s_add_u32 s68, s68, 2359296
    s_cmp_ge_u32 s63, 184
    s_cselect_b32 s66, s66, 10752
    s_mov_b32 m0, s66
    s_nop 0
    buffer_load_dwordx4 v40, s[52:55], s68 offen nt lds
    s_lshl_b32 s66, s3, 10
    s_add_u32 s66, s66, 52736
    s_mul_i32 s68, s3, 73728
    s_add_u32 s68, s68, 2949120
    s_cmp_ge_u32 s63, 184
    s_cselect_b32 s66, s66, 10752
    s_mov_b32 m0, s66
    s_nop 0
    buffer_load_dwordx4 v40, s[52:55], s68 offen nt lds
    s_lshl_b32 s66, s3, 10
    s_add_u32 s66, s66, 60928
    s_mul_i32 s68, s3, 73728
    s_add_u32 s68, s68, 3538944
    s_cmp_ge_u32 s63, 184
    s_cselect_b32 s66, s66, 10752
    s_mov_b32 m0, s66
    s_nop 0
    buffer_load_dwordx4 v40, s[52:55], s68 offen nt lds
    s_lshl_b32 s66, s3, 10
    s_add_u32 s66, s66, 69120
    s_mul_i32 s68, s3, 73728
    s_add_u32 s68, s68, 4128768
    s_cmp_ge_u32 s63, 184
    s_cselect_b32 s66, s66, 10752
    s_mov_b32 m0, s66
    s_nop 0
    buffer_load_dwordx4 v40, s[52:55], s68 offen nt lds
    s_lshl_b32 s66, s3, 10
    s_add_u32 s66, s66, 77312
    s_mul_i32 s68, s3, 73728
    s_add_u32 s68, s68, 4718592
    s_cmp_ge_u32 s63, 184
    s_cselect_b32 s66, s66, 10752
    s_mov_b32 m0, s66
    s_nop 0
    buffer_load_dwordx4 v40, s[52:55], s68 offen nt lds
    s_lshl_b32 s66, s3, 10
    s_add_u32 s66, s66, 118272
    s_mul_i32 s68, s3, 9216
    s_add_u32 s68, s68, 512
    s_mov_b32 m0, s66
    s_nop 0
    buffer_load_dwordx4 v39, s[76:79], s68 offen nt lds
    s_lshl_b32 s66, s3, 10
    s_add_u32 s66, s66, 126464
    s_mul_i32 s68, s3, 9216
    s_add_u32 s68, s68, 640
    s_mov_b32 m0, s66
    s_nop 0
    buffer_load_dwordx4 v39, s[76:79], s68 offen nt lds
    s_lshl_b32 s66, s3, 10
    s_add_u32 s66, s66, 134656
    s_mul_i32 s68, s3, 9216
    s_add_u32 s68, s68, 768
    s_mov_b32 m0, s66
    s_nop 0
    buffer_load_dwordx4 v39, s[76:79], s68 offen nt lds
    s_lshl_b32 s66, s3, 10
    s_add_u32 s66, s66, 142848
    s_mul_i32 s68, s3, 9216
    s_add_u32 s68, s68, 896
    s_mov_b32 m0, s66
    s_nop 0
    buffer_load_dwordx4 v39, s[76:79], s68 offen nt lds
    s_lshl_b32 s66, s3, 10
    s_add_u32 s66, s66, 151040
    s_mul_i32 s68, s3, 9216
    s_add_u32 s68, s68, 1024
    s_mov_b32 m0, s66
    s_nop 0
    buffer_load_dwordx4 v39, s[76:79], s68 offen nt lds
    v_lshlrev_b32 v113, 3, v41
    v_add_u32 v113, v113, v42
    v_lshlrev_b32 v113, 7, v113
    v_lshl_add_u32 v113, v43, 3, v113
    v_and_b32 v118, 1, v41
    v_lshlrev_b32 v118, 1, v118
    v_lshrrev_b32 v119, 1, v42
    v_or_b32 v118, v118, v119
    v_and_b32 v120, 7, v1
    v_mul_u32_u24 v121, 160, v120
    v_lshl_add_u32 v122, v41, 3, v121
    v_lshl_add_u32 v121, v41, 4, v121
    s_mul_i32 s85, s81, 18432
    s_add_u32 s85, s85, 1048576
    s_cmp_lt_u32 s3, 4
    s_cbranch_scc1 L_mlp_a
    s_sub_u32 s60, s3, 4
    s_lshl_b32 s66, s60, 13
    s_add_u32 s66, s66, 85504
    s_lshl_b32 s68, s60, 7
    s_and_b32 s61, s3, 1
    s_lshl_b32 s61, s61, 6
    v_xor_b32 v116, s61, v39
    v_xor_b32 v117, 64, v116
    s_add_u32 s61, s66, 0
    s_mov_b32 m0, s61
    s_add_u32 s61, s68, 0
    buffer_load_dwordx4 v116, s[76:79], s61 offen nt lds
    s_add_u32 s61, s66, 1024
    s_mov_b32 m0, s61
    s_add_u32 s61, s68, 9216
    buffer_load_dwordx4 v117, s[76:79], s61 offen nt lds
    s_add_u32 s61, s66, 2048
    s_mov_b32 m0, s61
    s_add_u32 s61, s68, 18432
    buffer_load_dwordx4 v116, s[76:79], s61 offen nt lds
    s_add_u32 s61, s66, 3072
    s_mov_b32 m0, s61
    s_add_u32 s61, s68, 27648
    buffer_load_dwordx4 v117, s[76:79], s61 offen nt lds
    s_add_u32 s61, s66, 4096
    s_mov_b32 m0, s61
    s_add_u32 s61, s68, 36864
    buffer_load_dwordx4 v116, s[76:79], s61 offen nt lds
    s_add_u32 s61, s66, 5120
    s_mov_b32 m0, s61
    s_add_u32 s61, s68, 46080
    buffer_load_dwordx4 v117, s[76:79], s61 offen nt lds
    s_add_u32 s61, s66, 6144
    s_mov_b32 m0, s61
    s_add_u32 s61, s68, 55296
    buffer_load_dwordx4 v116, s[76:79], s61 offen nt lds
    s_add_u32 s61, s66, 7168
    s_mov_b32 m0, s61
    s_add_u32 s61, s68, 64512
    buffer_load_dwordx4 v117, s[76:79], s61 offen nt lds
    v_add_u32 v113, s66, v113
    s_lshl_b32 s60, s60, 11
    s_add_u32 s85, s85, s60
    v_xor_b32 v119, 0, v118
    v_lshl_add_u32 v124, v119, 5, v113
    v_xor_b32 v119, 1, v118
    v_lshl_add_u32 v125, v119, 5, v113
    v_xor_b32 v119, 2, v118
    v_lshl_add_u32 v126, v119, 5, v113
    v_xor_b32 v119, 3, v118
    v_lshl_add_u32 v127, v119, 5, v113
    s_waitcnt vmcnt(8)
    s_barrier
    s_barrier
    s_waitcnt vmcnt(0)
    ds_read_b64_tr_b16 v[128:129], v124 offset:0
    ds_read_b64_tr_b16 v[130:131], v124 offset:512
    ds_read_b64_tr_b16 v[132:133], v124 offset:4096
    ds_read_b64_tr_b16 v[134:135], v124 offset:4608
    ds_read_b64_tr_b16 v[136:137], v125 offset:0
    ds_read_b64_tr_b16 v[138:139], v125 offset:512
    ds_read_b64_tr_b16 v[140:141], v125 offset:4096
    ds_read_b64_tr_b16 v[142:143], v125 offset:4608
    s_waitcnt lgkmcnt(4)
    ds_read_b64_tr_b16 v[144:145], v126 offset:0
    ds_read_b64_tr_b16 v[146:147], v126 offset:512
    ds_read_b64_tr_b16 v[148:149], v126 offset:4096
    ds_read_b64_tr_b16 v[150:151], v126 offset:4608
    ds_read_b64_tr_b16 v[152:153], v127 offset:0
    ds_read_b64_tr_b16 v[154:155], v127 offset:512
    ds_read_b64_tr_b16 v[156:157], v127 offset:4096
    ds_read_b64_tr_b16 v[158:159], v127 offset:4608
    s_waitcnt lgkmcnt(0)
    s_barrier
    ds_read_b128 v[64:67], v121 offset:9600
    ds_read_b128 v[68:71], v121 offset:9664
    s_waitcnt lgkmcnt(0)
    v_mfma_f32_16x16x32_bf16 v[192:195], v[128:131], v[64:67], 0
    v_mfma_f32_16x16x32_bf16 v[196:199], v[136:139], v[64:67], 0
    v_mfma_f32_16x16x32_bf16 v[192:195], v[132:135], v[68:71], v[192:195]
    v_mfma_f32_16x16x32_bf16 v[196:199], v[140:143], v[68:71], v[196:199]
    v_mfma_f32_16x16x32_bf16 v[200:203], v[144:147], v[64:67], 0
    v_mfma_f32_16x16x32_bf16 v[204:207], v[152:155], v[64:67], 0
    v_mfma_f32_16x16x32_bf16 v[200:203], v[148:151], v[68:71], v[200:203]
    v_mfma_f32_16x16x32_bf16 v[204:207], v[156:159], v[68:71], v[204:207]
    s_nop 3
    v_cndmask_b32 v224, v192, v196, s[88:89]
    v_cndmask_b32 v225, v193, v197, s[88:89]
    v_cndmask_b32 v226, v194, v198, s[88:89]
    v_cndmask_b32 v227, v195, v199, s[88:89]
    v_bfi_b32 v224, s69, v224, v54
    v_bfi_b32 v225, s69, v225, v55
    v_bfi_b32 v226, s69, v226, v54
    v_bfi_b32 v227, s69, v227, v55
    buffer_store_dwordx4 v[224:227], v3, s[36:39], s85 offen offset:0 sc1
    v_cndmask_b32 v228, v200, v204, s[88:89]
    v_cndmask_b32 v229, v201, v205, s[88:89]
    v_cndmask_b32 v230, v202, v206, s[88:89]
    v_cndmask_b32 v231, v203, v207, s[88:89]
    v_bfi_b32 v228, s69, v228, v54
    v_bfi_b32 v229, s69, v229, v55
    v_bfi_b32 v230, s69, v230, v54
    v_bfi_b32 v231, s69, v231, v55
    buffer_store_dwordx4 v[228:231], v3, s[36:39], s85 offen offset:1024 sc1
    s_branch L_nmlp
L_mlp_a:
    s_and_b32 s68, s3, 1
    s_lshl_b32 s68, s68, 1
    v_xor_b32 v119, s68, v118
    v_lshl_add_u32 v114, v119, 5, v113
    v_add_u32 v114, 151040, v114
    v_xor_b32 v115, 32, v114
    s_lshl_b32 s68, s3, 13
    s_add_u32 s68, s68, 118272
    v_lshl_add_u32 v108, v118, 5, v113
    v_add_u32 v108, s68, v108
    v_xor_b32 v109, 32, v108
    v_xor_b32 v110, 64, v108
    v_xor_b32 v123, 96, v108
    v_xor_b32 v119, s3, v118
    v_lshl_add_u32 v113, v119, 5, v113
    v_add_u32 v113, 11776, v113
    v_lshrrev_b32 v116, 5, v1
    v_and_b32 v117, 31, v1
    v_mul_u32_u24 v111, 2304, v116
    v_lshl_add_u32 v112, v117, 3, v111
    v_lshl_add_u32 v111, v117, 4, v111
    s_mul_i32 s67, s3, 4608
    s_add_u32 s67, s67, 6291456
    v_mul_u32_u24 v124, 1184, v116
    s_mul_i32 s66, s3, 2368
    v_add_u32 v124, s66, v124
    v_lshl_add_u32 v125, v117, 2, v124
    v_lshl_add_u32 v124, v117, 3, v124
    v_mul_u32_u24 v120, 1184, v120
    v_lshl_add_u32 v120, v41, 4, v120
    s_lshl_b32 s66, s3, 5
    v_add_u32 v122, s66, v122
    s_and_b32 s66, s3, 1
    s_lshl_b32 s66, s66, 10
    s_add_u32 s84, s85, s66
    s_add_u32 s84, s84, 16384
    s_lshl_b32 s66, s3, 11
    s_add_u32 s85, s85, s66
    s_add_u32 s85, s85, 8192
    s_waitcnt vmcnt(0)
    s_barrier
    s_mov_b32 s80, 0
    buffer_load_dwordx4 v[16:19], v111, s[36:39], s67 offen offset:0 sc1
    buffer_load_dwordx4 v[20:23], v111, s[36:39], s67 offen offset:512 sc1
    buffer_load_dwordx4 v[24:27], v111, s[36:39], s67 offen offset:1024 sc1
    buffer_load_dwordx4 v[28:31], v111, s[36:39], s67 offen offset:1536 sc1
    buffer_load_dwordx2 v[32:33], v112, s[36:39], s67 offen offset:2048 sc1
    ds_read_b64_tr_b16 v[128:129], v113 offset:0
    ds_read_b64_tr_b16 v[130:131], v113 offset:512
    ds_read_b64_tr_b16 v[132:133], v113 offset:4096
    ds_read_b64_tr_b16 v[134:135], v113 offset:4608
    ds_read_b64_tr_b16 v[136:137], v113 offset:8192
    ds_read_b64_tr_b16 v[138:139], v113 offset:8704
    ds_read_b64_tr_b16 v[140:141], v113 offset:12288
    ds_read_b64_tr_b16 v[142:143], v113 offset:12800
    ds_read_b64_tr_b16 v[144:145], v113 offset:16384
    ds_read_b64_tr_b16 v[146:147], v113 offset:16896
    ds_read_b64_tr_b16 v[148:149], v113 offset:20480
    ds_read_b64_tr_b16 v[150:151], v113 offset:20992
    s_waitcnt lgkmcnt(0)
    ds_read_b64_tr_b16 v[152:153], v113 offset:24576
    ds_read_b64_tr_b16 v[154:155], v113 offset:25088
    ds_read_b64_tr_b16 v[156:157], v113 offset:28672
    ds_read_b64_tr_b16 v[158:159], v113 offset:29184
    ds_read_b64_tr_b16 v[160:161], v113 offset:32768
    ds_read_b64_tr_b16 v[162:163], v113 offset:33280
    v_add_u32 v113, 36864, v113
    ds_read_b64_tr_b16 v[164:165], v113 offset:0
    ds_read_b64_tr_b16 v[166:167], v113 offset:512
    ds_read_b64_tr_b16 v[168:169], v113 offset:4096
    ds_read_b64_tr_b16 v[170:171], v113 offset:4608
    ds_read_b64_tr_b16 v[172:173], v113 offset:8192
    ds_read_b64_tr_b16 v[174:175], v113 offset:8704
    s_waitcnt lgkmcnt(0)
    ds_read_b64_tr_b16 v[176:177], v113 offset:12288
    ds_read_b64_tr_b16 v[178:179], v113 offset:12800
    ds_read_b64_tr_b16 v[180:181], v113 offset:16384
    ds_read_b64_tr_b16 v[182:183], v113 offset:16896
    ds_read_b64_tr_b16 v[184:185], v113 offset:20480
    ds_read_b64_tr_b16 v[186:187], v113 offset:20992
    ds_read_b64_tr_b16 v[188:189], v113 offset:24576
    ds_read_b64_tr_b16 v[190:191], v113 offset:25088
    ds_read_b64_tr_b16 v[192:193], v113 offset:28672
    ds_read_b64_tr_b16 v[194:195], v113 offset:29184
    ds_read_b64_tr_b16 v[196:197], v113 offset:32768
    ds_read_b64_tr_b16 v[198:199], v113 offset:33280
    s_waitcnt lgkmcnt(0)
    ds_read_b64_tr_b16 v[200:201], v108 offset:0
    ds_read_b64_tr_b16 v[202:203], v108 offset:512
    ds_read_b64_tr_b16 v[204:205], v108 offset:4096
    ds_read_b64_tr_b16 v[206:207], v108 offset:4608
    ds_read_b64_tr_b16 v[208:209], v109 offset:0
    ds_read_b64_tr_b16 v[210:211], v109 offset:512
    ds_read_b64_tr_b16 v[212:213], v109 offset:4096
    ds_read_b64_tr_b16 v[214:215], v109 offset:4608
    s_waitcnt lgkmcnt(0)
    ds_read_b64_tr_b16 v[216:217], v110 offset:0
    ds_read_b64_tr_b16 v[218:219], v110 offset:512
    ds_read_b64_tr_b16 v[220:221], v110 offset:4096
    ds_read_b64_tr_b16 v[222:223], v110 offset:4608
    ds_read_b64_tr_b16 v[224:225], v123 offset:0
    ds_read_b64_tr_b16 v[226:227], v123 offset:512
    ds_read_b64_tr_b16 v[228:229], v123 offset:4096
    ds_read_b64_tr_b16 v[230:231], v123 offset:4608
    s_waitcnt lgkmcnt(0)
    s_cmp_lt_u32 s3, 2
    s_cbranch_scc1 L_af_done
    ds_read_b64_tr_b16 v[232:233], v114 offset:0
    ds_read_b64_tr_b16 v[234:235], v114 offset:512
    ds_read_b64_tr_b16 v[236:237], v114 offset:4096
    ds_read_b64_tr_b16 v[238:239], v114 offset:4608
    ds_read_b64_tr_b16 v[240:241], v115 offset:0
    ds_read_b64_tr_b16 v[242:243], v115 offset:512
    ds_read_b64_tr_b16 v[244:245], v115 offset:4096
    ds_read_b64_tr_b16 v[246:247], v115 offset:4608
    s_waitcnt lgkmcnt(0)
L_af_done:
    s_branch L_pfirst_12
L_poll_10:
    s_add_u32 s80, s80, 1
    s_cmp_gt_u32 s80, 1000000
    s_cbranch_scc1 L_pdone_11
    s_sleep 1
    buffer_load_dwordx4 v[16:19], v111, s[36:39], s67 offen offset:0 sc1
    buffer_load_dwordx4 v[20:23], v111, s[36:39], s67 offen offset:512 sc1
    buffer_load_dwordx4 v[24:27], v111, s[36:39], s67 offen offset:1024 sc1
    buffer_load_dwordx4 v[28:31], v111, s[36:39], s67 offen offset:1536 sc1
    buffer_load_dwordx2 v[32:33], v112, s[36:39], s67 offen offset:2048 sc1
L_pfirst_12:
    s_waitcnt vmcnt(0)
    v_xor_b32 v16, s90, v16
    v_xor_b32 v17, s91, v17
    v_xor_b32 v18, s90, v18
    v_xor_b32 v19, s91, v19
    v_xor_b32 v20, s90, v20
    v_xor_b32 v21, s91, v21
    v_xor_b32 v22, s90, v22
    v_xor_b32 v23, s91, v23
    v_xor_b32 v24, s90, v24
    v_xor_b32 v25, s91, v25
    v_xor_b32 v26, s90, v26
    v_xor_b32 v27, s91, v27
    v_xor_b32 v28, s90, v28
    v_xor_b32 v29, s91, v29
    v_xor_b32 v30, s90, v30
    v_xor_b32 v31, s91, v31
    v_xor_b32 v32, s90, v32
    v_xor_b32 v33, s91, v33
    v_or_b32 v126, v16, v17
    v_or3_b32 v126, v126, v18, v19
    v_or3_b32 v126, v126, v20, v21
    v_or3_b32 v126, v126, v22, v23
    v_or3_b32 v126, v126, v24, v25
    v_or3_b32 v126, v126, v26, v27
    v_or3_b32 v126, v126, v28, v29
    v_or3_b32 v126, v126, v30, v31
    v_or3_b32 v126, v126, v32, v33
    v_and_b32 v126, 0xffff, v126
    v_cmp_ne_u32 vcc, 0, v126
    s_nop 0
    s_mov_b64 exec, vcc
    s_cbranch_vccnz L_poll_10
L_pdone_11:
    s_mov_b64 exec, -1
    v_pk_add_f32 v[56:57], v[16:17], v[18:19]
    v_pk_add_f32 v[58:59], v[20:21], v[22:23]
    v_pk_add_f32 v[56:57], v[56:57], v[24:25]
    v_pk_add_f32 v[58:59], v[58:59], v[26:27]
    v_pk_add_f32 v[56:57], v[56:57], v[28:29]
    v_pk_add_f32 v[58:59], v[58:59], v[30:31]
    v_pk_add_f32 v[56:57], v[56:57], v[32:33]
    v_pk_add_f32 v[56:57], v[56:57], v[58:59]
    v_add_f32 v56, v56, v57
    s_nop 1
    v_add_f32_dpp v56, v56, v56 row_ror:8 row_mask:0xf bank_mask:0xf
    s_nop 1
    v_add_f32_dpp v56, v56, v56 row_ror:4 row_mask:0xf bank_mask:0xf
    s_nop 1
    v_add_f32_dpp v56, v56, v56 row_ror:2 row_mask:0xf bank_mask:0xf
    s_nop 1
    v_add_f32_dpp v56, v56, v56 row_ror:1 row_mask:0xf bank_mask:0xf
    v_mov_b32 v58, v56
    s_nop 1
    v_permlane16_swap_b32 v56, v58
    v_add_f32 v56, v56, v58
    v_mul_f32 v56, 0xbae38e39, v56
    v_mov_b32 v57, v56
    v_cvt_pk_bf16_f32 v64, v56, v56
    v_pk_add_f32 v[58:59], v[16:17], v[56:57]
    v_and_b32 v64, 0xffff0000, v64
    v_pk_add_f32 v[62:63], v[18:19], v[56:57]
    v_pk_mul_f32 v[60:61], v[58:59], v[58:59]
    v_pk_add_f32 v[58:59], v[20:21], v[56:57]
    v_pk_fma_f32 v[60:61], v[62:63], v[62:63], v[60:61]
    v_pk_add_f32 v[62:63], v[22:23], v[56:57]
    v_pk_fma_f32 v[60:61], v[58:59], v[58:59], v[60:61]
    v_pk_add_f32 v[58:59], v[24:25], v[56:57]
    v_pk_fma_f32 v[60:61], v[62:63], v[62:63], v[60:61]
    v_pk_add_f32 v[62:63], v[26:27], v[56:57]
    v_pk_fma_f32 v[60:61], v[58:59], v[58:59], v[60:61]
    v_pk_add_f32 v[58:59], v[28:29], v[56:57]
    v_pk_fma_f32 v[60:61], v[62:63], v[62:63], v[60:61]
    v_pk_add_f32 v[62:63], v[30:31], v[56:57]
    v_pk_fma_f32 v[60:61], v[58:59], v[58:59], v[60:61]
    v_pk_add_f32 v[58:59], v[32:33], v[56:57]
    v_pk_fma_f32 v[60:61], v[62:63], v[62:63], v[60:61]
    v_mov_b32 v65, v64
    v_pk_fma_f32 v[60:61], v[58:59], v[58:59], v[60:61]
    v_add_f32 v60, v60, v61
    v_pk_add_f32 v[16:17], v[16:17], v[64:65]
    v_pk_add_f32 v[18:19], v[18:19], v[64:65]
    v_add_f32_dpp v60, v60, v60 row_ror:8 row_mask:0xf bank_mask:0xf
    v_pk_add_f32 v[20:21], v[20:21], v[64:65]
    v_pk_add_f32 v[22:23], v[22:23], v[64:65]
    v_add_f32_dpp v60, v60, v60 row_ror:4 row_mask:0xf bank_mask:0xf
    v_pk_add_f32 v[24:25], v[24:25], v[64:65]
    v_pk_add_f32 v[26:27], v[26:27], v[64:65]
    v_add_f32_dpp v60, v60, v60 row_ror:2 row_mask:0xf bank_mask:0xf
    v_pk_add_f32 v[28:29], v[28:29], v[64:65]
    v_pk_add_f32 v[30:31], v[30:31], v[64:65]
    v_add_f32_dpp v60, v60, v60 row_ror:1 row_mask:0xf bank_mask:0xf
    v_pk_add_f32 v[32:33], v[32:33], v[64:65]
    v_cvt_pk_bf16_f32 v4, v16, v17
    v_mov_b32 v58, v60
    v_cvt_pk_bf16_f32 v5, v18, v19
    v_cvt_pk_bf16_f32 v6, v20, v21
    v_permlane16_swap_b32 v60, v58
    v_cvt_pk_bf16_f32 v7, v22, v23
    v_cvt_pk_bf16_f32 v8, v24, v25
    v_add_f32 v60, v60, v58
    v_cvt_pk_bf16_f32 v9, v26, v27
    v_cvt_pk_bf16_f32 v10, v28, v29
    v_mul_f32 v60, 0x3ae38e39, v60
    v_cvt_pk_bf16_f32 v11, v30, v31
    v_cvt_pk_bf16_f32 v12, v32, v33
    v_cvt_pk_bf16_f32 v60, v60, v60
    v_lshlrev_b32 v16, 16, v4
    v_and_b32 v17, 0xffff0000, v4
    v_and_b32 v60, 0xffff0000, v60
    v_lshlrev_b32 v18, 16, v5
    v_and_b32 v19, 0xffff0000, v5
    v_add_f32 v60, 0x3727c5ac, v60
    v_lshlrev_b32 v20, 16, v6
    v_and_b32 v21, 0xffff0000, v6
    v_cvt_pk_bf16_f32 v60, v60, v60
    v_lshlrev_b32 v22, 16, v7
    v_and_b32 v23, 0xffff0000, v7
    v_and_b32 v60, 0xffff0000, v60
    v_lshlrev_b32 v24, 16, v8
    v_and_b32 v25, 0xffff0000, v8
    v_sqrt_f32 v60, v60
    v_lshlrev_b32 v26, 16, v9
    v_and_b32 v27, 0xffff0000, v9
    v_cvt_pk_bf16_f32 v60, v60, v60
    v_lshlrev_b32 v28, 16, v10
    v_and_b32 v29, 0xffff0000, v10
    v_and_b32 v60, 0xffff0000, v60
    v_lshlrev_b32 v30, 16, v11
    v_and_b32 v31, 0xffff0000, v11
    v_rcp_f32 v60, v60
    v_lshlrev_b32 v32, 16, v12
    v_and_b32 v33, 0xffff0000, v12
    v_mov_b32 v61, v60
    v_pk_mul_f32 v[16:17], v[16:17], v[60:61]
    v_pk_mul_f32 v[18:19], v[18:19], v[60:61]
    v_pk_mul_f32 v[20:21], v[20:21], v[60:61]
    v_pk_mul_f32 v[22:23], v[22:23], v[60:61]
    v_pk_mul_f32 v[24:25], v[24:25], v[60:61]
    v_pk_mul_f32 v[26:27], v[26:27], v[60:61]
    v_pk_mul_f32 v[28:29], v[28:29], v[60:61]
    v_pk_mul_f32 v[30:31], v[30:31], v[60:61]
    v_pk_mul_f32 v[32:33], v[32:33], v[60:61]
    v_cvt_pk_bf16_f32 v4, v16, v17
    v_cvt_pk_bf16_f32 v5, v18, v19
    v_cvt_pk_bf16_f32 v6, v20, v21
    v_cvt_pk_bf16_f32 v7, v22, v23
    v_cvt_pk_bf16_f32 v8, v24, v25
    v_cvt_pk_bf16_f32 v9, v26, v27
    v_cvt_pk_bf16_f32 v10, v28, v29
    v_cvt_pk_bf16_f32 v11, v30, v31
    v_cvt_pk_bf16_f32 v12, v32, v33
    ds_write_b64 v124, v[4:5] offset:0
    ds_write_b64 v124, v[6:7] offset:256
    ds_write_b64 v124, v[8:9] offset:512
    ds_write_b64 v124, v[10:11] offset:768
    ds_write_b32 v125, v12 offset:1024
    s_waitcnt lgkmcnt(0)
    s_barrier
    ds_read_b128 v[56:59], v120 offset:0
    ds_read_b128 v[60:63], v120 offset:64
    ds_read_b128 v[64:67], v120 offset:128
    ds_read_b128 v[68:71], v120 offset:192
    ds_read_b128 v[72:75], v120 offset:256
    ds_read_b128 v[76:79], v120 offset:320
    ds_read_b128 v[80:83], v120 offset:384
    ds_read_b128 v[84:87], v120 offset:448
    ds_read_b128 v[88:91], v120 offset:512
    s_waitcnt lgkmcnt(8)
    v_mfma_f32_16x16x32_bf16 v[24:27], v[128:131], v[56:59], 0
    ds_read_b128 v[92:95], v120 offset:576
    s_waitcnt lgkmcnt(8)
    v_mfma_f32_16x16x32_bf16 v[24:27], v[132:135], v[60:63], v[24:27]
    ds_read_b128 v[96:99], v120 offset:640
    s_waitcnt lgkmcnt(8)
    v_mfma_f32_16x16x32_bf16 v[24:27], v[136:139], v[64:67], v[24:27]
    ds_read_b128 v[100:103], v120 offset:704
    s_waitcnt lgkmcnt(8)
    v_mfma_f32_16x16x32_bf16 v[24:27], v[140:143], v[68:71], v[24:27]
    ds_read_b128 v[104:107], v120 offset:768
    s_waitcnt lgkmcnt(8)
    v_mfma_f32_16x16x32_bf16 v[24:27], v[144:147], v[72:75], v[24:27]
    ds_read_b128 v[56:59], v120 offset:832
    s_waitcnt lgkmcnt(8)
    v_mfma_f32_16x16x32_bf16 v[24:27], v[148:151], v[76:79], v[24:27]
    ds_read_b128 v[60:63], v120 offset:896
    s_waitcnt lgkmcnt(8)
    v_mfma_f32_16x16x32_bf16 v[24:27], v[152:155], v[80:83], v[24:27]
    ds_read_b128 v[64:67], v120 offset:960
    s_waitcnt lgkmcnt(8)
    v_mfma_f32_16x16x32_bf16 v[24:27], v[156:159], v[84:87], v[24:27]
    ds_read_b128 v[68:71], v120 offset:1024
    s_waitcnt lgkmcnt(8)
    v_mfma_f32_16x16x32_bf16 v[24:27], v[160:163], v[88:91], v[24:27]
    ds_read_b128 v[72:75], v120 offset:1088
    s_waitcnt lgkmcnt(8)
    v_mfma_f32_16x16x32_bf16 v[24:27], v[164:167], v[92:95], v[24:27]
    s_waitcnt lgkmcnt(7)
    v_mfma_f32_16x16x32_bf16 v[24:27], v[168:171], v[96:99], v[24:27]
    s_waitcnt lgkmcnt(6)
    v_mfma_f32_16x16x32_bf16 v[24:27], v[172:175], v[100:103], v[24:27]
    s_waitcnt lgkmcnt(5)
    v_mfma_f32_16x16x32_bf16 v[24:27], v[176:179], v[104:107], v[24:27]
    s_waitcnt lgkmcnt(4)
    v_mfma_f32_16x16x32_bf16 v[24:27], v[180:183], v[56:59], v[24:27]
    s_waitcnt lgkmcnt(3)
    v_mfma_f32_16x16x32_bf16 v[24:27], v[184:187], v[60:63], v[24:27]
    s_waitcnt lgkmcnt(2)
    v_mfma_f32_16x16x32_bf16 v[24:27], v[188:191], v[64:67], v[24:27]
    s_waitcnt lgkmcnt(1)
    v_mfma_f32_16x16x32_bf16 v[24:27], v[192:195], v[68:71], v[24:27]
    s_waitcnt lgkmcnt(0)
    v_mfma_f32_16x16x32_bf16 v[24:27], v[196:199], v[72:75], v[24:27]
    s_nop 7
    v_max_f32 v24, 0, v24
    v_max_f32 v25, 0, v25
    v_max_f32 v26, 0, v26
    v_max_f32 v27, 0, v27
    v_cvt_pk_bf16_f32 v24, v24, v25
    v_cvt_pk_bf16_f32 v25, v26, v27
    ds_write_b64 v122, v[24:25] offset:9600
    s_waitcnt lgkmcnt(0)
    s_barrier
    ds_read_b128 v[64:67], v121 offset:9600
    ds_read_b128 v[68:71], v121 offset:9664
    s_waitcnt lgkmcnt(0)
    v_mfma_f32_16x16x32_bf16 v[128:131], v[200:203], v[64:67], 0
    v_mfma_f32_16x16x32_bf16 v[132:135], v[208:211], v[64:67], 0
    v_mfma_f32_16x16x32_bf16 v[128:131], v[204:207], v[68:71], v[128:131]
    v_mfma_f32_16x16x32_bf16 v[132:135], v[212:215], v[68:71], v[132:135]
    v_mfma_f32_16x16x32_bf16 v[136:139], v[216:219], v[64:67], 0
    v_mfma_f32_16x16x32_bf16 v[140:143], v[224:227], v[64:67], 0
    v_mfma_f32_16x16x32_bf16 v[136:139], v[220:223], v[68:71], v[136:139]
    v_mfma_f32_16x16x32_bf16 v[140:143], v[228:231], v[68:71], v[140:143]
    s_cmp_lt_u32 s3, 2
    s_cbranch_scc1 L_a_two
    v_mfma_f32_16x16x32_bf16 v[144:147], v[232:235], v[64:67], 0
    v_mfma_f32_16x16x32_bf16 v[148:151], v[240:243], v[64:67], 0
    v_mfma_f32_16x16x32_bf16 v[144:147], v[236:239], v[68:71], v[144:147]
    v_mfma_f32_16x16x32_bf16 v[148:151], v[244:247], v[68:71], v[148:151]
    v_cndmask_b32 v160, v128, v132, s[88:89]
    v_cndmask_b32 v161, v129, v133, s[88:89]
    v_cndmask_b32 v162, v130, v134, s[88:89]
    v_cndmask_b32 v163, v131, v135, s[88:89]
    v_bfi_b32 v160, s69, v160, v54
    v_bfi_b32 v161, s69, v161, v55
    v_bfi_b32 v162, s69, v162, v54
    v_bfi_b32 v163, s69, v163, v55
    buffer_store_dwordx4 v[160:163], v3, s[36:39], s85 offen offset:0 sc1
    v_cndmask_b32 v164, v136, v140, s[88:89]
    v_cndmask_b32 v165, v137, v141, s[88:89]
    v_cndmask_b32 v166, v138, v142, s[88:89]
    v_cndmask_b32 v167, v139, v143, s[88:89]
    v_bfi_b32 v164, s69, v164, v54
    v_bfi_b32 v165, s69, v165, v55
    v_bfi_b32 v166, s69, v166, v54
    v_bfi_b32 v167, s69, v167, v55
    buffer_store_dwordx4 v[164:167], v3, s[36:39], s85 offen offset:1024 sc1
    v_cndmask_b32 v168, v144, v148, s[88:89]
    v_cndmask_b32 v169, v145, v149, s[88:89]
    v_cndmask_b32 v170, v146, v150, s[88:89]
    v_cndmask_b32 v171, v147, v151, s[88:89]
    v_bfi_b32 v168, s69, v168, v54
    v_bfi_b32 v169, s69, v169, v55
    v_bfi_b32 v170, s69, v170, v54
    v_bfi_b32 v171, s69, v171, v55
    buffer_store_dwordx4 v[168:171], v3, s[36:39], s84 offen sc1
    s_branch L_a_done
L_a_two:
    s_nop 4
    v_cndmask_b32 v160, v128, v132, s[88:89]
    v_cndmask_b32 v161, v129, v133, s[88:89]
    v_cndmask_b32 v162, v130, v134, s[88:89]
    v_cndmask_b32 v163, v131, v135, s[88:89]
    v_bfi_b32 v160, s69, v160, v54
    v_bfi_b32 v161, s69, v161, v55
    v_bfi_b32 v162, s69, v162, v54
    v_bfi_b32 v163, s69, v163, v55
    buffer_store_dwordx4 v[160:163], v3, s[36:39], s85 offen offset:0 sc1
    v_cndmask_b32 v164, v136, v140, s[88:89]
    v_cndmask_b32 v165, v137, v141, s[88:89]
    v_cndmask_b32 v166, v138, v142, s[88:89]
    v_cndmask_b32 v167, v139, v143, s[88:89]
    v_bfi_b32 v164, s69, v164, v54
    v_bfi_b32 v165, s69, v165, v55
    v_bfi_b32 v166, s69, v166, v54
    v_bfi_b32 v167, s69, v167, v55
    buffer_store_dwordx4 v[164:167], v3, s[36:39], s85 offen offset:1024 sc1
L_a_done:
L_nmlp:
    s_cmp_ge_u32 s63, 144
    s_cbranch_scc1 L_fin
    s_cmp_lg_u32 s3, 6
    s_cbranch_scc1 L_fin
    v_and_b32 v120, 7, v1
    v_lshrrev_b32 v121, 3, v1
    v_mul_u32_u24 v111, 18432, v121
    v_lshl_add_u32 v111, v120, 4, v111
    s_lshr_b32 s74, s63, 3
    s_lshl_b32 s74, s74, 5
    s_and_b32 s75, s63, 1
    s_lshl_b32 s75, s75, 4
    s_add_u32 s74, s74, s75
    s_bfe_u32 s75, s63, 0x20001
    s_lshl_b32 s75, s75, 2
    s_add_u32 s74, s74, s75
    s_lshl_b32 s83, s74, 1
    s_lshl_b32 s84, s74, 2
    s_add_u32 s84, s84, 6291456
    s_lshl_b32 s66, s63, 7
    s_add_u32 s66, s66, 1048576
    v_mul_u32_u24 v112, 1152, v120
    v_mul_u32_u24 v113, 2304, v120
    s_mov_b32 s80, 0
    buffer_load_dwordx4 v[96:99], v113, s[36:39], s84 offen sc1
    s_branch L_pfirst_15
L_poll_13:
    s_add_u32 s80, s80, 1
    s_cmp_gt_u32 s80, 1000000
    s_cbranch_scc1 L_pdone_14
    s_sleep 2
    buffer_load_dwordx4 v[96:99], v113, s[36:39], s84 offen sc1
L_pfirst_15:
    s_waitcnt vmcnt(0)
    v_xor_b32 v96, s90, v96
    v_xor_b32 v97, s91, v97
    v_xor_b32 v98, s90, v98
    v_xor_b32 v99, s91, v99
    v_or_b32 v102, v96, v97
    v_or3_b32 v102, v102, v98, v99
    v_and_b32 v102, 0xffff, v102
    v_cmp_ne_u32 vcc, 0, v102
    s_nop 0
    s_mov_b64 exec, vcc
    s_cbranch_vccnz L_poll_13
L_pdone_14:
    s_mov_b64 exec, -1
    s_mov_b32 s80, 0
    s_add_u32 s68, s66, 0
    buffer_load_dwordx4 v[128:131], v111, s[36:39], s68 offen sc1
    s_add_u32 s68, s66, 147456
    buffer_load_dwordx4 v[132:135], v111, s[36:39], s68 offen sc1
    s_add_u32 s68, s66, 294912
    buffer_load_dwordx4 v[136:139], v111, s[36:39], s68 offen sc1
    s_add_u32 s68, s66, 442368
    buffer_load_dwordx4 v[140:143], v111, s[36:39], s68 offen sc1
    s_add_u32 s68, s66, 589824
    buffer_load_dwordx4 v[144:147], v111, s[36:39], s68 offen sc1
    s_add_u32 s68, s66, 737280
    buffer_load_dwordx4 v[148:151], v111, s[36:39], s68 offen sc1
    s_add_u32 s68, s66, 884736
    buffer_load_dwordx4 v[152:155], v111, s[36:39], s68 offen sc1
    s_add_u32 s68, s66, 1032192
    buffer_load_dwordx4 v[156:159], v111, s[36:39], s68 offen sc1
    s_add_u32 s68, s66, 1179648
    buffer_load_dwordx4 v[160:163], v111, s[36:39], s68 offen sc1
    s_branch L_pfirst_18
L_poll_16:
    s_add_u32 s80, s80, 1
    s_cmp_gt_u32 s80, 1000000
    s_cbranch_scc1 L_pdone_17
    s_add_u32 s68, s66, 0
    buffer_load_dwordx4 v[128:131], v111, s[36:39], s68 offen sc1
    s_add_u32 s68, s66, 147456
    buffer_load_dwordx4 v[132:135], v111, s[36:39], s68 offen sc1
    s_add_u32 s68, s66, 294912
    buffer_load_dwordx4 v[136:139], v111, s[36:39], s68 offen sc1
    s_add_u32 s68, s66, 442368
    buffer_load_dwordx4 v[140:143], v111, s[36:39], s68 offen sc1
    s_add_u32 s68, s66, 589824
    buffer_load_dwordx4 v[144:147], v111, s[36:39], s68 offen sc1
    s_add_u32 s68, s66, 737280
    buffer_load_dwordx4 v[148:151], v111, s[36:39], s68 offen sc1
    s_add_u32 s68, s66, 884736
    buffer_load_dwordx4 v[152:155], v111, s[36:39], s68 offen sc1
    s_add_u32 s68, s66, 1032192
    buffer_load_dwordx4 v[156:159], v111, s[36:39], s68 offen sc1
    s_add_u32 s68, s66, 1179648
    buffer_load_dwordx4 v[160:163], v111, s[36:39], s68 offen sc1
L_pfirst_18:
    s_waitcnt vmcnt(0)
    v_xor_b32 v128, s92, v128
    v_xor_b32 v129, s93, v129
    v_xor_b32 v130, s92, v130
    v_xor_b32 v131, s93, v131
    v_xor_b32 v132, s92, v132
    v_xor_b32 v133, s93, v133
    v_xor_b32 v134, s92, v134
    v_xor_b32 v135, s93, v135
    v_xor_b32 v136, s92, v136
    v_xor_b32 v137, s93, v137
    v_xor_b32 v138, s92, v138
    v_xor_b32 v139, s93, v139
    v_xor_b32 v140, s92, v140
    v_xor_b32 v141, s93, v141
    v_xor_b32 v142, s92, v142
    v_xor_b32 v143, s93, v143
    v_xor_b32 v144, s92, v144
    v_xor_b32 v145, s93, v145
    v_xor_b32 v146, s92, v146
    v_xor_b32 v147, s93, v147
    v_xor_b32 v148, s92, v148
    v_xor_b32 v149, s93, v149
    v_xor_b32 v150, s92, v150
    v_xor_b32 v151, s93, v151
    v_xor_b32 v152, s92, v152
    v_xor_b32 v153, s93, v153
    v_xor_b32 v154, s92, v154
    v_xor_b32 v155, s93, v155
    v_xor_b32 v156, s92, v156
    v_xor_b32 v157, s93, v157
    v_xor_b32 v158, s92, v158
    v_xor_b32 v159, s93, v159
    v_xor_b32 v160, s92, v160
    v_xor_b32 v161, s93, v161
    v_xor_b32 v162, s92, v162
    v_xor_b32 v163, s93, v163
    v_or_b32 v102, v128, v129
    v_or3_b32 v102, v102, v130, v131
    v_or3_b32 v102, v102, v132, v133
    v_or3_b32 v102, v102, v134, v135
    v_or3_b32 v102, v102, v136, v137
    v_or3_b32 v102, v102, v138, v139
    v_or3_b32 v102, v102, v140, v141
    v_or3_b32 v102, v102, v142, v143
    v_or3_b32 v102, v102, v144, v145
    v_or3_b32 v102, v102, v146, v147
    v_or3_b32 v102, v102, v148, v149
    v_or3_b32 v102, v102, v150, v151
    v_or3_b32 v102, v102, v152, v153
    v_or3_b32 v102, v102, v154, v155
    v_or3_b32 v102, v102, v156, v157
    v_or3_b32 v102, v102, v158, v159
    v_or3_b32 v102, v102, v160, v161
    v_or3_b32 v102, v102, v162, v163
    v_and_b32 v102, 0x3ff, v102
    v_cmp_ne_u32 vcc, 0, v102
    s_nop 0
    s_mov_b64 exec, vcc
    s_cbranch_vccnz L_poll_16
L_pdone_17:
    s_mov_b64 exec, -1
    v_pk_add_f32 v[128:129], v[128:129], v[132:133]
    v_pk_add_f32 v[130:131], v[130:131], v[134:135]
    v_pk_add_f32 v[128:129], v[128:129], v[136:137]
    v_pk_add_f32 v[130:131], v[130:131], v[138:139]
    v_pk_add_f32 v[128:129], v[128:129], v[140:141]
    v_pk_add_f32 v[130:131], v[130:131], v[142:143]
    v_pk_add_f32 v[128:129], v[128:129], v[144:145]
    v_pk_add_f32 v[130:131], v[130:131], v[146:147]
    v_pk_add_f32 v[128:129], v[128:129], v[148:149]
    v_pk_add_f32 v[130:131], v[130:131], v[150:151]
    v_pk_add_f32 v[128:129], v[128:129], v[152:153]
    v_pk_add_f32 v[130:131], v[130:131], v[154:155]
    v_pk_add_f32 v[128:129], v[128:129], v[156:157]
    v_pk_add_f32 v[130:131], v[130:131], v[158:159]
    v_pk_add_f32 v[128:129], v[128:129], v[160:161]
    v_pk_add_f32 v[130:131], v[130:131], v[162:163]
    s_nop 0
    v_add_f32_dpp v128, v128, v128 row_ror:8 row_mask:0xf bank_mask:0xf
    v_add_f32_dpp v129, v129, v129 row_ror:8 row_mask:0xf bank_mask:0xf
    v_add_f32_dpp v130, v130, v130 row_ror:8 row_mask:0xf bank_mask:0xf
    v_add_f32_dpp v131, v131, v131 row_ror:8 row_mask:0xf bank_mask:0xf
    v_mov_b32 v132, v128
    v_mov_b32 v133, v129
    v_mov_b32 v134, v130
    v_mov_b32 v135, v131
    v_permlane16_swap_b32 v128, v132
    v_permlane16_swap_b32 v129, v133
    v_permlane16_swap_b32 v130, v134
    v_permlane16_swap_b32 v131, v135
    v_pk_add_f32 v[128:129], v[128:129], v[132:133]
    v_pk_add_f32 v[130:131], v[130:131], v[134:135]
    v_mov_b32 v132, v128
    v_mov_b32 v133, v129
    v_mov_b32 v134, v130
    v_mov_b32 v135, v131
    v_permlane32_swap_b32 v128, v132
    v_permlane32_swap_b32 v129, v133
    v_permlane32_swap_b32 v130, v134
    v_permlane32_swap_b32 v131, v135
    v_pk_add_f32 v[128:129], v[128:129], v[132:133]
    v_pk_add_f32 v[130:131], v[130:131], v[134:135]
    v_cvt_pk_bf16_f32 v128, v128, v129
    v_cvt_pk_bf16_f32 v130, v130, v131
    v_and_b32 v129, 0xffff0000, v128
    v_lshlrev_b32 v128, 16, v128
    v_and_b32 v131, 0xffff0000, v130
    v_lshlrev_b32 v130, 16, v130
    v_pk_add_f32 v[128:129], v[128:129], v[96:97]
    v_pk_add_f32 v[130:131], v[130:131], v[98:99]
    v_cvt_pk_bf16_f32 v128, v128, v129
    v_cvt_pk_bf16_f32 v129, v130, v131
    s_mov_b64 exec, 0xff
    buffer_store_dwordx2 v[128:129], v112, s[56:59], s83 offen sc1
    s_cmp_lg_u32 s2, 0
    s_cbranch_scc1 L_nep
    s_mov_b64 exec, 1
    v_mov_b32 v130, s97
    s_mov_b32 s66, 0
    buffer_store_dword v130, v112, s[36:39], s66 offen sc1
    v_mov_b32 v131, s98
    s_mov_b32 s66, 7340032
    buffer_store_dword v131, v112, s[36:39], s66 offen sc1
L_nep:
    s_mov_b64 exec, -1
L_fin:
L_end:
    s_endpgm

.section .rodata,"a"
.p2align 6
.amdhsa_kernel sequential_preLN__sliding_block_cached__dense_activation_relu__decode_kernel
  .amdhsa_next_free_vgpr 256
  .amdhsa_next_free_sgpr 102
  .amdhsa_accum_offset 256
  .amdhsa_group_segment_fixed_size 0
  .amdhsa_kernarg_size 88
  .amdhsa_user_sgpr_count 2
  .amdhsa_user_sgpr_kernarg_segment_ptr 1
  .amdhsa_system_sgpr_workgroup_id_x 1
.end_amdhsa_kernel
```
